```python
import torch

def _softmax(x, axis=-1):
    return torch.softmax(x, dim=axis)
def _gelu(x):
    return torch.nn.functional.gelu(x, approximate="tanh")
def _silu(x):
    return torch.nn.functional.silu(x)
def _sigmoid(x):
    return torch.sigmoid(x)
def _layernorm(x, axis=-1, eps=1e-5):
    m = x.mean(dim=axis, keepdim=True)
    v = x.var(dim=axis, keepdim=True, unbiased=False)
    return (x - m) / torch.sqrt(v + eps)
def _scatter_add(tgt, idx, src, axis=0):
    return tgt.clone().index_add_(axis, idx, src)
def _segment_sum(src, seg, n):
    out = torch.zeros((n,) + src.shape[1:], dtype=src.dtype)
    return out.index_add_(0, seg, src)
def _pad(x, pw):
    flat = tuple(v for pair in reversed(pw) for v in pair)
    return torch.nn.functional.pad(x, flat)

kernel_name = 'recurrent_scan__sliding_block_cached__glu_gated_bilinear__decode'

def setup_inputs():

    _w = (lambda a: (lambda t: t.to(torch.bfloat16) if t.is_floating_point() else t)(torch.as_tensor(a)))
    def _A_setup():
        B, Sq, D = 1, 1, 640
        Hq, Hkv, Sk, Dh = 32, 32, 8192, 192
        assert Hq % Hkv == 0, (Hq, Hkv)
        return {
            "x": _w((lambda *s: torch.randn(*s, dtype=torch.bfloat16) * 0.2)(B, Sq, D)),
            "k_cache": _w((lambda *s: torch.randn(*s, dtype=torch.bfloat16) * 1.6)(B, Hkv, Sk, Dh)),
            "v_cache": _w((lambda *s: torch.randn(*s, dtype=torch.bfloat16) * 1.6)(B, Hkv, Sk, Dh)),
            "wq": _w((lambda *s: torch.randn(*s, dtype=torch.bfloat16) * 1.6)(D, Hq * Dh) * (D ** -0.5)),
            "wo": _w((lambda *s: torch.randn(*s, dtype=torch.bfloat16) * 1.6)(Hq * Dh, D) * ((Hq * Dh) ** -0.5)),
        }
    _A_in = _A_setup()

    def _B_setup():
        B, S, D, F = 1, 1, 640, 1536
        return {
            "x": _w((lambda *s: torch.randn(*s, dtype=torch.bfloat16) * 0.2)(B, S, D)),
            "w_gate": _w((lambda *s: torch.randn(*s, dtype=torch.bfloat16) * 0.8)(D, F) * (D ** -0.5)),
            "w_up": _w((lambda *s: torch.randn(*s, dtype=torch.bfloat16) * 0.8)(D, F) * (D ** -0.5)),
            "w_down": _w((lambda *s: torch.randn(*s, dtype=torch.bfloat16) * 0.8)(F, D) * (F ** -0.5)),
        }
    _B_in = _B_setup()

    return {
        "A_x": _A_in["x"],
        "A_k_cache": _A_in["k_cache"],
        "A_v_cache": _A_in["v_cache"],
        "A_wq": _A_in["wq"],
        "A_wo": _A_in["wo"],
        "B_x": _B_in["x"],
        "B_w_gate": _B_in["w_gate"],
        "B_w_up": _B_in["w_up"],
        "B_w_down": _B_in["w_down"],
    }

def reference(A_x, A_k_cache, A_v_cache, A_wq, A_wo, B_x, B_w_gate, B_w_up, B_w_down):
    def _A_ref(x, k_cache, v_cache, wq, wo):
        B, Sq, D = x.shape
        Hq, Dh = 32, 192
        Hkv, Sk = k_cache.shape[1], k_cache.shape[2]
        W = min(4096, max(256, Sk // 4))
        rep = Hq // Hkv
        q = (lambda x, *d: x.permute(*d))((x @ wq).reshape(B, Sq, Hq, Dh), 0, 2, 1, 3)
        k = (lambda x, n, axis: torch.repeat_interleave(x, n, dim=axis))(k_cache[:, :, Sk - W:, :], rep, axis=1)
        v = (lambda x, n, axis: torch.repeat_interleave(x, n, dim=axis))(v_cache[:, :, Sk - W:, :], rep, axis=1)
        scores = torch.einsum("bhqd,bhkd->bhqk", q, k) * (Dh ** -0.5)
        p = _softmax(scores, axis=-1)
        o = torch.einsum("bhqk,bhkd->bhqd", p, v)
        return (lambda x, *d: x.permute(*d))(o, 0, 2, 1, 3).reshape(B, Sq, Hq * Dh) @ wo

    def _B_ref(x, w_gate, w_up, w_down):
        g = torch.einsum("bsd,df->bsf", x, w_gate)
        u = torch.einsum("bsd,df->bsf", x, w_up)
        h = g * u
        return torch.einsum("bsf,fd->bsd", h, w_down)

    x = A_x
    xn = _layernorm(x, axis=-1)
    s = _A_ref(xn, A_k_cache, A_v_cache, A_wq, A_wo)
    g = _silu(_B_ref(xn, B_w_gate, B_w_up, B_w_down))
    return x + s * g
```

```asm
; @launch grid=(256,1,1) block=(512,1,1) lds=4096
.amdgcn_target "amdgcn-amd-amdhsa--gfx950"
.text
.globl recurrent_scan__sliding_block_cached__glu_gated_bilinear__decode_kernel
.p2align 8
.type recurrent_scan__sliding_block_cached__glu_gated_bilinear__decode_kernel,@function
recurrent_scan__sliding_block_cached__glu_gated_bilinear__decode_kernel:
L_start:
    s_cmp_ge_u32 s2, 256
    s_cbranch_scc1 L_end
    s_load_dwordx16 s[4:19], s[0:1], 0
    s_load_dwordx8 s[20:27], s[0:1], 64
    v_lshrrev_b32 v8, 6, v0
    v_and_b32 v1, 63, v0
    v_readfirstlane_b32 s3, v8
    s_lshr_b32 s49, s2, 3
    v_lshlrev_b32 v14, 4, v1
    s_cmp_lg_u32 s3, 7
    s_cbranch_scc1 L_nopf
    s_getpc_b64 s[60:61]
L_pc:
    s_sub_u32 s60, s60, L_pc-L_start
    s_subb_u32 s61, s61, 0
    s_mov_b32 s62, L_codeend-L_start
    s_mov_b32 s63, 0x00020000
    s_and_b32 s54, s49, 3
    s_mul_i32 s54, s54, 3072
    buffer_load_dwordx4 v[132:135], v14, s[60:63], s54 offen offset:0
    buffer_load_dwordx4 v[132:135], v14, s[60:63], s54 offen offset:1024
    buffer_load_dwordx4 v[132:135], v14, s[60:63], s54 offen offset:2048
L_nopf:
    v_lshrrev_b32 v2, 3, v1
    v_and_b32 v3, 7, v1
    v_mov_b32 v13, 0
    v_lshlrev_b32 v10, 2, v3
    ds_write_b32 v10, v13
    s_and_b32 s48, s2, 7
    s_lshl_b32 s46, s48, 2
    s_lshr_b32 s50, s49, 3
    s_add_u32 s46, s46, s50
    s_and_b32 s47, s49, 7
    s_mul_i32 s50, s46, 3145728
    s_mul_i32 s52, s47, 3072
    s_add_u32 s50, s50, s52
    s_add_u32 s50, s50, 2359296
    v_mul_u32_u24 v11, 384, v2
    v_lshlrev_b32 v12, 4, v3
    v_add_u32 v11, v11, v12
    s_mov_b32 s30, 100663296
    s_mov_b32 s31, 0x00020000
    s_mov_b32 s34, 402653184
    s_mov_b32 s35, 0x00020000
    s_mov_b32 s39, 0x00020000
    s_mov_b32 s42, 1280
    s_mov_b32 s43, 0x00020000
    s_mul_i32 s54, s49, 205
    s_lshr_b32 s54, s54, 10
    s_mul_i32 s55, s54, 5
    s_sub_u32 s55, s49, s55
    s_lshl_b32 s56, s48, 2
    s_add_u32 s56, s56, s54
    s_lshl_b32 s57, s54, 3
    s_add_u32 s57, s57, s48
    s_cmp_lt_u32 s54, 4
    s_cselect_b32 s54, s56, s57
    s_mov_b32 s58, 3072
    s_cselect_b32 s58, 12288, s58
    s_mov_b32 s38, 1966080
    s_cselect_b32 s38, 7864320, s38
    s_and_b32 s57, s54, 7
    s_cmp_lt_u32 s54, 32
    s_cselect_b32 s57, s54, s57
    s_mul_i32 s57, s57, 384
    s_lshl_b32 s59, s3, 7
    s_add_u32 s57, s57, s59
    s_lshl_b32 s59, s55, 7
    s_mul_i32 s59, s59, s58
    s_add_u32 s57, s57, s59
    s_lshl_b32 s59, s58, 4
    v_mul_lo_u32 v9, v2, s59
    v_add_u32 v9, v9, v12
    v_lshlrev_b32 v10, 2, v1
    v_lshlrev_b32 v15, 5, v2
    s_lshl_b32 s56, s55, 8
    s_getreg_b32 s75, hwreg(HW_REG_XCC_ID)
    s_lshl_b32 s77, s48, 8
    s_add_u32 s77, s77, 4096
    s_sub_u32 s53, s3, 3
    s_mul_i32 s52, s53, 24576
    s_add_u32 s52, s52, s50
    s_cmp_ge_u32 s3, 3
    s_waitcnt lgkmcnt(0)
    s_cbranch_scc1 L_kwave
    s_cmp_ge_u32 s49, 30
    s_cbranch_scc1 L_vb0
    s_mov_b32 s40, s4
    s_mov_b32 s41, s5
    s_cmp_lt_u32 s54, 40
    s_cselect_b32 s36, s16, s18
    s_cselect_b32 s37, s17, s19
    s_cmp_lt_u32 s54, 32
    s_cselect_b32 s36, s10, s36
    s_cselect_b32 s37, s11, s37
    buffer_load_dwordx4 v[80:83], v14, s[40:43], 0 offen
    buffer_load_dword v84, v10, s[40:43], 0 offen offset:1024
    buffer_load_dwordx4 v[88:91], v15, s[40:43], s56 offen
    buffer_load_dwordx4 v[92:95], v15, s[40:43], s56 offen offset:16
    buffer_load_dwordx4 v[16:19], v9, s[36:39], s57 offen nt
    s_add_u32 s57, s57, s58
    buffer_load_dwordx4 v[20:23], v9, s[36:39], s57 offen nt
    s_add_u32 s57, s57, s58
    buffer_load_dwordx4 v[24:27], v9, s[36:39], s57 offen nt
    s_add_u32 s57, s57, s58
    buffer_load_dwordx4 v[28:31], v9, s[36:39], s57 offen nt
    s_add_u32 s57, s57, s58
    buffer_load_dwordx4 v[32:35], v9, s[36:39], s57 offen nt
    s_add_u32 s57, s57, s58
    buffer_load_dwordx4 v[36:39], v9, s[36:39], s57 offen nt
    s_add_u32 s57, s57, s58
    buffer_load_dwordx4 v[40:43], v9, s[36:39], s57 offen nt
    s_add_u32 s57, s57, s58
    buffer_load_dwordx4 v[44:47], v9, s[36:39], s57 offen nt
    s_add_u32 s57, s57, s58
    buffer_load_dwordx4 v[48:51], v9, s[36:39], s57 offen nt
    s_add_u32 s57, s57, s58
    buffer_load_dwordx4 v[52:55], v9, s[36:39], s57 offen nt
    s_add_u32 s57, s57, s58
    buffer_load_dwordx4 v[56:59], v9, s[36:39], s57 offen nt
    s_add_u32 s57, s57, s58
    buffer_load_dwordx4 v[60:63], v9, s[36:39], s57 offen nt
    s_add_u32 s57, s57, s58
    buffer_load_dwordx4 v[64:67], v9, s[36:39], s57 offen nt
    s_add_u32 s57, s57, s58
    buffer_load_dwordx4 v[68:71], v9, s[36:39], s57 offen nt
    s_add_u32 s57, s57, s58
    buffer_load_dwordx4 v[72:75], v9, s[36:39], s57 offen nt
    s_add_u32 s57, s57, s58
    buffer_load_dwordx4 v[76:79], v9, s[36:39], s57 offen nt
L_vb0:
    s_barrier
    s_branch L_vwave
L_kwave:
    s_mov_b32 s28, s6
    s_mov_b32 s29, s7
    s_load_dword s45, s[26:27], 0
    s_mov_b32 s32, s26
    s_mov_b32 s33, s27
    s_setprio 2
    s_cmp_lg_u32 s53, 4
    s_cbranch_scc1 L_kb0
    s_waitcnt lgkmcnt(0)
    s_mul_i32 s44, s45, 0x9E3779B1
    s_add_u32 s44, s44, 0x7F4A7C15
    v_mov_b32 v136, s75
    v_mov_b32 v137, s44
    s_lshl_b32 s54, s49, 3
    s_add_u32 s54, s54, s77
    s_mov_b64 exec, 1
    buffer_store_dwordx2 v[136:137], v13, s[32:35], s54 offen
    s_mov_b64 exec, -1
    s_barrier
    v_and_b32 v8, 1, v3
    v_lshlrev_b32 v8, 4, v8
    v_mov_b32 v9, 0xffff
    v_lshlrev_b32 v9, v8, v9
    v_lshrrev_b32 v8, 1, v3
    v_cmp_eq_u32 vcc, 0, v8
    s_nop 1
    v_cndmask_b32 v4, 0, v9, vcc
    v_cmp_eq_u32 vcc, 1, v8
    s_nop 1
    v_cndmask_b32 v5, 0, v9, vcc
    v_cmp_eq_u32 vcc, 2, v8
    s_nop 1
    v_cndmask_b32 v6, 0, v9, vcc
    v_cmp_eq_u32 vcc, 3, v8
    s_nop 1
    v_cndmask_b32 v7, 0, v9, vcc
    s_branch L_kprep
L_kb0:
    s_barrier
    buffer_load_dwordx4 v[16:19], v11, s[28:31], s52 offen offset:0 nt
    buffer_load_dwordx4 v[20:23], v11, s[28:31], s52 offen offset:128 nt
    buffer_load_dwordx4 v[24:27], v11, s[28:31], s52 offen offset:256 nt
    s_add_u32 s52, s52, 98304
    buffer_load_dwordx4 v[28:31], v11, s[28:31], s52 offen offset:0 nt
    buffer_load_dwordx4 v[32:35], v11, s[28:31], s52 offen offset:128 nt
    buffer_load_dwordx4 v[36:39], v11, s[28:31], s52 offen offset:256 nt
    s_add_u32 s52, s52, 98304
    buffer_load_dwordx4 v[40:43], v11, s[28:31], s52 offen offset:0 nt
    buffer_load_dwordx4 v[44:47], v11, s[28:31], s52 offen offset:128 nt
    buffer_load_dwordx4 v[48:51], v11, s[28:31], s52 offen offset:256 nt
    s_add_u32 s52, s52, 98304
    buffer_load_dwordx4 v[52:55], v11, s[28:31], s52 offen offset:0 nt
    buffer_load_dwordx4 v[56:59], v11, s[28:31], s52 offen offset:128 nt
    buffer_load_dwordx4 v[60:63], v11, s[28:31], s52 offen offset:256 nt
    s_add_u32 s52, s52, 98304
    buffer_load_dwordx4 v[64:67], v11, s[28:31], s52 offen offset:0 nt
    buffer_load_dwordx4 v[68:71], v11, s[28:31], s52 offen offset:128 nt
    buffer_load_dwordx4 v[72:75], v11, s[28:31], s52 offen offset:256 nt
    s_add_u32 s52, s52, 98304
    buffer_load_dwordx4 v[76:79], v11, s[28:31], s52 offen offset:0 nt
    buffer_load_dwordx4 v[80:83], v11, s[28:31], s52 offen offset:128 nt
    buffer_load_dwordx4 v[84:87], v11, s[28:31], s52 offen offset:256 nt
    s_add_u32 s52, s52, 98304
    buffer_load_dwordx4 v[88:91], v11, s[28:31], s52 offen offset:0 nt
    buffer_load_dwordx4 v[92:95], v11, s[28:31], s52 offen offset:128 nt
    buffer_load_dwordx4 v[96:99], v11, s[28:31], s52 offen offset:256 nt
    s_add_u32 s52, s52, 98304
    buffer_load_dwordx4 v[100:103], v11, s[28:31], s52 offen offset:0 nt
    buffer_load_dwordx4 v[104:107], v11, s[28:31], s52 offen offset:128 nt
    buffer_load_dwordx4 v[108:111], v11, s[28:31], s52 offen offset:256 nt
    v_and_b32 v8, 1, v3
    v_lshlrev_b32 v8, 4, v8
    v_mov_b32 v9, 0xffff
    v_lshlrev_b32 v9, v8, v9
    v_lshrrev_b32 v8, 1, v3
    v_cmp_eq_u32 vcc, 0, v8
    s_nop 1
    v_cndmask_b32 v4, 0, v9, vcc
    v_cmp_eq_u32 vcc, 1, v8
    s_nop 1
    v_cndmask_b32 v5, 0, v9, vcc
    v_cmp_eq_u32 vcc, 2, v8
    s_nop 1
    v_cndmask_b32 v6, 0, v9, vcc
    v_cmp_eq_u32 vcc, 3, v8
    s_nop 1
    v_cndmask_b32 v7, 0, v9, vcc
    s_waitcnt lgkmcnt(0)
    s_mul_i32 s44, s45, 0x9E3779B1
    s_add_u32 s44, s44, 0x7F4A7C15
    v_mov_b32 v143, 1
    v_and_b32 v8, 31, v1
    v_lshlrev_b32 v8, 3, v8
    buffer_load_dwordx2 v[154:155], v8, s[32:35], s77 offen sc1
    s_cmp_eq_u32 s53, 3
    s_cbranch_scc1 L_qwait
    v_lshlrev_b32 v14, 3, v1
    s_lshl_b32 s54, s46, 14
    s_lshl_b32 s55, s53, 9
    s_add_u32 s54, s54, s55
    s_add_u32 s54, s54, 1245184
    s_add_u32 s55, s54, 4096
    s_add_u32 s56, s54, 8192
    v_lshrrev_b32 v8, 5, v1
    v_lshlrev_b32 v8, 2, v8
    v_bfe_u32 v9, v1, 4, 1
    v_add_u32 v8, v8, v9
    v_and_b32 v9, 1, v1
    v_lshl_add_u32 v8, v9, 1, v8
    v_lshlrev_b32 v8, 3, v8
    v_bfe_u32 v9, v1, 1, 3
    v_add_u32 v8, v8, v9
    s_lshl_b32 s57, s53, 6
    v_add_u32 v8, s57, v8
    v_lshlrev_b32 v15, 1, v8
    s_mov_b32 s51, 20000
Lpoll_1:
    buffer_load_dwordx2 v[132:133], v14, s[32:35], s54 offen offset:0 sc1
    buffer_load_dwordx2 v[134:135], v14, s[32:35], s54 offen offset:2048 sc1
    buffer_load_dwordx2 v[136:137], v14, s[32:35], s55 offen offset:0 sc1
    buffer_load_dwordx2 v[138:139], v14, s[32:35], s55 offen offset:2048 sc1
    buffer_load_dwordx2 v[140:141], v14, s[32:35], s56 offen offset:0 sc1
    s_waitcnt vmcnt(0)
    v_xor_b32 v142, s44, v133
    v_bitop3_b32 v142, v135, s44, v142 bitop3:0xbe
    v_bitop3_b32 v142, v137, s44, v142 bitop3:0xbe
    v_bitop3_b32 v142, v139, s44, v142 bitop3:0xbe
    v_bitop3_b32 v142, v141, s44, v142 bitop3:0xbe
    v_cmp_ne_u32 vcc, 0, v142
    s_cbranch_vccz Lpollok_2
    s_sub_u32 s51, s51, 1
    s_cbranch_scc0 Lpoll_1
Lpollok_2:
    v_add_f32 v142, v132, v134
    v_add_f32 v136, v136, v138
    v_add_f32 v142, v142, v140
    v_add_f32 v142, v142, v136
    v_cvt_pk_bf16_f32 v142, v142, v142
    ds_write_b16 v15, v142 offset:128
    s_mov_b64 exec, 1
    ds_add_u32 v13, v143 offset:0
    s_mov_b64 exec, -1
L_qwait:
    s_waitcnt vmcnt(0)
    v_xor_b32 v8, s44, v155
    v_bitop3_b32 v8, v154, s75, v8 bitop3:0xbe
    v_cmp_ne_u32 vcc, 0, v8
    s_cmp_eq_u64 vcc, 0
    s_cselect_b32 s74, 1, 0
    s_mov_b32 s51, 160000
Lspin_3:
    ds_read_b32 v142, v13 offset:0
    s_waitcnt lgkmcnt(0)
    v_readfirstlane_b32 s52, v142
    s_cmp_ge_u32 s52, 3
    s_cbranch_scc1 Lspinok_4
    s_sleep 1
    s_sub_u32 s51, s51, 1
    s_cbranch_scc0 Lspin_3
Lspinok_4:
    ds_read_b128 v[112:115], v12 offset:128
    ds_read_b128 v[116:119], v12 offset:256
    ds_read_b128 v[120:123], v12 offset:384
    s_waitcnt lgkmcnt(0)
    v_dot2_f32_bf16 v124, v16, v112, 0
    v_dot2_f32_bf16 v125, v28, v112, 0
    v_dot2_f32_bf16 v126, v40, v112, 0
    v_dot2_f32_bf16 v127, v52, v112, 0
    v_dot2_f32_bf16 v128, v64, v112, 0
    v_dot2_f32_bf16 v129, v76, v112, 0
    v_dot2_f32_bf16 v130, v88, v112, 0
    v_dot2_f32_bf16 v131, v100, v112, 0
    v_dot2c_f32_bf16 v124, v17, v113
    v_dot2c_f32_bf16 v125, v29, v113
    v_dot2c_f32_bf16 v126, v41, v113
    v_dot2c_f32_bf16 v127, v53, v113
    v_dot2c_f32_bf16 v128, v65, v113
    v_dot2c_f32_bf16 v129, v77, v113
    v_dot2c_f32_bf16 v130, v89, v113
    v_dot2c_f32_bf16 v131, v101, v113
    v_dot2c_f32_bf16 v124, v18, v114
    v_dot2c_f32_bf16 v125, v30, v114
    v_dot2c_f32_bf16 v126, v42, v114
    v_dot2c_f32_bf16 v127, v54, v114
    v_dot2c_f32_bf16 v128, v66, v114
    v_dot2c_f32_bf16 v129, v78, v114
    v_dot2c_f32_bf16 v130, v90, v114
    v_dot2c_f32_bf16 v131, v102, v114
    v_dot2c_f32_bf16 v124, v19, v115
    v_dot2c_f32_bf16 v125, v31, v115
    v_dot2c_f32_bf16 v126, v43, v115
    v_dot2c_f32_bf16 v127, v55, v115
    v_dot2c_f32_bf16 v128, v67, v115
    v_dot2c_f32_bf16 v129, v79, v115
    v_dot2c_f32_bf16 v130, v91, v115
    v_dot2c_f32_bf16 v131, v103, v115
    v_dot2c_f32_bf16 v124, v20, v116
    v_dot2c_f32_bf16 v125, v32, v116
    v_dot2c_f32_bf16 v126, v44, v116
    v_dot2c_f32_bf16 v127, v56, v116
    v_dot2c_f32_bf16 v128, v68, v116
    v_dot2c_f32_bf16 v129, v80, v116
    v_dot2c_f32_bf16 v130, v92, v116
    v_dot2c_f32_bf16 v131, v104, v116
    v_dot2c_f32_bf16 v124, v21, v117
    v_dot2c_f32_bf16 v125, v33, v117
    v_dot2c_f32_bf16 v126, v45, v117
    v_dot2c_f32_bf16 v127, v57, v117
    v_dot2c_f32_bf16 v128, v69, v117
    v_dot2c_f32_bf16 v129, v81, v117
    v_dot2c_f32_bf16 v130, v93, v117
    v_dot2c_f32_bf16 v131, v105, v117
    v_dot2c_f32_bf16 v124, v22, v118
    v_dot2c_f32_bf16 v125, v34, v118
    v_dot2c_f32_bf16 v126, v46, v118
    v_dot2c_f32_bf16 v127, v58, v118
    v_dot2c_f32_bf16 v128, v70, v118
    v_dot2c_f32_bf16 v129, v82, v118
    v_dot2c_f32_bf16 v130, v94, v118
    v_dot2c_f32_bf16 v131, v106, v118
    v_dot2c_f32_bf16 v124, v23, v119
    v_dot2c_f32_bf16 v125, v35, v119
    v_dot2c_f32_bf16 v126, v47, v119
    v_dot2c_f32_bf16 v127, v59, v119
    v_dot2c_f32_bf16 v128, v71, v119
    v_dot2c_f32_bf16 v129, v83, v119
    v_dot2c_f32_bf16 v130, v95, v119
    v_dot2c_f32_bf16 v131, v107, v119
    v_dot2c_f32_bf16 v124, v24, v120
    v_dot2c_f32_bf16 v125, v36, v120
    v_dot2c_f32_bf16 v126, v48, v120
    v_dot2c_f32_bf16 v127, v60, v120
    v_dot2c_f32_bf16 v128, v72, v120
    v_dot2c_f32_bf16 v129, v84, v120
    v_dot2c_f32_bf16 v130, v96, v120
    v_dot2c_f32_bf16 v131, v108, v120
    v_dot2c_f32_bf16 v124, v25, v121
    v_dot2c_f32_bf16 v125, v37, v121
    v_dot2c_f32_bf16 v126, v49, v121
    v_dot2c_f32_bf16 v127, v61, v121
    v_dot2c_f32_bf16 v128, v73, v121
    v_dot2c_f32_bf16 v129, v85, v121
    v_dot2c_f32_bf16 v130, v97, v121
    v_dot2c_f32_bf16 v131, v109, v121
    v_dot2c_f32_bf16 v124, v26, v122
    v_dot2c_f32_bf16 v125, v38, v122
    v_dot2c_f32_bf16 v126, v50, v122
    v_dot2c_f32_bf16 v127, v62, v122
    v_dot2c_f32_bf16 v128, v74, v122
    v_dot2c_f32_bf16 v129, v86, v122
    v_dot2c_f32_bf16 v130, v98, v122
    v_dot2c_f32_bf16 v131, v110, v122
    v_dot2c_f32_bf16 v124, v27, v123
    v_dot2c_f32_bf16 v125, v39, v123
    v_dot2c_f32_bf16 v126, v51, v123
    v_dot2c_f32_bf16 v127, v63, v123
    v_dot2c_f32_bf16 v128, v75, v123
    v_dot2c_f32_bf16 v129, v87, v123
    v_dot2c_f32_bf16 v130, v99, v123
    v_dot2c_f32_bf16 v131, v111, v123
    v_add_f32_dpp v124, v124, v124 quad_perm:[1,0,3,2] row_mask:0xf bank_mask:0xf
    v_add_f32_dpp v125, v125, v125 quad_perm:[1,0,3,2] row_mask:0xf bank_mask:0xf
    v_add_f32_dpp v126, v126, v126 quad_perm:[1,0,3,2] row_mask:0xf bank_mask:0xf
    v_add_f32_dpp v127, v127, v127 quad_perm:[1,0,3,2] row_mask:0xf bank_mask:0xf
    v_add_f32_dpp v128, v128, v128 quad_perm:[1,0,3,2] row_mask:0xf bank_mask:0xf
    v_add_f32_dpp v129, v129, v129 quad_perm:[1,0,3,2] row_mask:0xf bank_mask:0xf
    v_add_f32_dpp v130, v130, v130 quad_perm:[1,0,3,2] row_mask:0xf bank_mask:0xf
    v_add_f32_dpp v131, v131, v131 quad_perm:[1,0,3,2] row_mask:0xf bank_mask:0xf
    v_add_f32_dpp v124, v124, v124 quad_perm:[2,3,0,1] row_mask:0xf bank_mask:0xf
    v_add_f32_dpp v125, v125, v125 quad_perm:[2,3,0,1] row_mask:0xf bank_mask:0xf
    v_add_f32_dpp v126, v126, v126 quad_perm:[2,3,0,1] row_mask:0xf bank_mask:0xf
    v_add_f32_dpp v127, v127, v127 quad_perm:[2,3,0,1] row_mask:0xf bank_mask:0xf
    v_add_f32_dpp v128, v128, v128 quad_perm:[2,3,0,1] row_mask:0xf bank_mask:0xf
    v_add_f32_dpp v129, v129, v129 quad_perm:[2,3,0,1] row_mask:0xf bank_mask:0xf
    v_add_f32_dpp v130, v130, v130 quad_perm:[2,3,0,1] row_mask:0xf bank_mask:0xf
    v_add_f32_dpp v131, v131, v131 quad_perm:[2,3,0,1] row_mask:0xf bank_mask:0xf
    v_add_f32_dpp v124, v124, v124 row_half_mirror row_mask:0xf bank_mask:0xf
    v_add_f32_dpp v125, v125, v125 row_half_mirror row_mask:0xf bank_mask:0xf
    v_add_f32_dpp v126, v126, v126 row_half_mirror row_mask:0xf bank_mask:0xf
    v_add_f32_dpp v127, v127, v127 row_half_mirror row_mask:0xf bank_mask:0xf
    v_add_f32_dpp v128, v128, v128 row_half_mirror row_mask:0xf bank_mask:0xf
    v_add_f32_dpp v129, v129, v129 row_half_mirror row_mask:0xf bank_mask:0xf
    v_add_f32_dpp v130, v130, v130 row_half_mirror row_mask:0xf bank_mask:0xf
    v_add_f32_dpp v131, v131, v131 row_half_mirror row_mask:0xf bank_mask:0xf
    s_mov_b32 s58, 0x3d93cd3a
    s_mov_b32 s59, 0xffff0000
    v_cvt_pk_bf16_f32 v142, v124, v125
    v_lshlrev_b32 v144, 16, v142
    v_and_b32 v145, s59, v142
    v_mul_f32 v144, s58, v144
    v_mul_f32 v145, s58, v145
    v_cvt_pk_bf16_f32 v142, v144, v145
    v_lshlrev_b32 v144, 16, v142
    v_and_b32 v145, s59, v142
    v_cvt_pk_bf16_f32 v142, v126, v127
    v_lshlrev_b32 v146, 16, v142
    v_and_b32 v147, s59, v142
    v_mul_f32 v146, s58, v146
    v_mul_f32 v147, s58, v147
    v_cvt_pk_bf16_f32 v142, v146, v147
    v_lshlrev_b32 v146, 16, v142
    v_and_b32 v147, s59, v142
    v_cvt_pk_bf16_f32 v142, v128, v129
    v_lshlrev_b32 v148, 16, v142
    v_and_b32 v149, s59, v142
    v_mul_f32 v148, s58, v148
    v_mul_f32 v149, s58, v149
    v_cvt_pk_bf16_f32 v142, v148, v149
    v_lshlrev_b32 v148, 16, v142
    v_and_b32 v149, s59, v142
    v_cvt_pk_bf16_f32 v142, v130, v131
    v_lshlrev_b32 v150, 16, v142
    v_and_b32 v151, s59, v142
    v_mul_f32 v150, s58, v150
    v_mul_f32 v151, s58, v151
    v_cvt_pk_bf16_f32 v142, v150, v151
    v_lshlrev_b32 v150, 16, v142
    v_and_b32 v151, s59, v142
    v_max3_f32 v152, v144, v145, v146
    v_max3_f32 v152, v152, v147, v148
    v_max3_f32 v152, v152, v149, v150
    v_max_f32 v152, v152, v151
    s_nop 1
    v_max_f32_dpp v152, v152, v152 row_ror:8 row_mask:0xf bank_mask:0xf
    v_mov_b32 v142, v152
    s_nop 1
    v_permlane16_swap_b32 v152, v142
    s_nop 0
    v_max_f32 v152, v152, v142
    v_mov_b32 v142, v152
    s_nop 1
    v_permlane32_swap_b32 v152, v142
    s_nop 0
    v_max_f32 v152, v152, v142
    s_mov_b32 s58, 0x3fb8aa3b
    v_sub_f32 v144, v144, v152
    v_sub_f32 v145, v145, v152
    v_sub_f32 v146, v146, v152
    v_sub_f32 v147, v147, v152
    v_sub_f32 v148, v148, v152
    v_sub_f32 v149, v149, v152
    v_sub_f32 v150, v150, v152
    v_sub_f32 v151, v151, v152
    v_mul_f32 v144, s58, v144
    v_mul_f32 v145, s58, v145
    v_mul_f32 v146, s58, v146
    v_mul_f32 v147, s58, v147
    v_mul_f32 v148, s58, v148
    v_mul_f32 v149, s58, v149
    v_mul_f32 v150, s58, v150
    v_mul_f32 v151, s58, v151
    v_exp_f32 v144, v144
    v_exp_f32 v145, v145
    v_exp_f32 v146, v146
    v_exp_f32 v147, v147
    v_exp_f32 v148, v148
    v_exp_f32 v149, v149
    v_exp_f32 v150, v150
    v_exp_f32 v151, v151
    s_nop 0
    v_add_f32 v153, v144, v145
    v_add_f32 v153, v153, v146
    v_add_f32 v153, v153, v147
    v_add_f32 v153, v153, v148
    v_add_f32 v153, v153, v149
    v_add_f32 v153, v153, v150
    v_add_f32 v153, v153, v151
    s_nop 1
    v_add_f32_dpp v153, v153, v153 row_ror:8 row_mask:0xf bank_mask:0xf
    v_mov_b32 v142, v153
    s_nop 1
    v_permlane16_swap_b32 v153, v142
    s_nop 0
    v_add_f32 v153, v153, v142
    v_mov_b32 v142, v153
    s_nop 1
    v_permlane32_swap_b32 v153, v142
    s_nop 0
    v_add_f32 v153, v153, v142
    v_mul_u32_u24 v8, 144, v2
    s_lshl_b32 s57, s53, 5
    v_add_u32 v8, s57, v8
    s_lshl_b32 s57, s53, 3
    v_mov_b32 v9, s57
    s_mov_b32 s56, 0x01010101
    s_mov_b32 s57, 0x01010101
    s_mov_b64 exec, s[56:57]
    ds_write_b128 v8, v[144:147] offset:512
    ds_write_b128 v8, v[148:151] offset:528
    s_mov_b64 exec, 1
    ds_write_b64 v9, v[152:153] offset:64
    ds_add_rtn_u32 v142, v13, v143 offset:16
    s_mov_b64 exec, -1
    s_waitcnt lgkmcnt(0)
    v_readfirstlane_b32 s52, v142
    s_cmp_lg_u32 s52, 3
    s_cbranch_scc1 L_kprep
    ds_read_b128 v[112:115], v13 offset:64
    ds_read_b128 v[116:119], v13 offset:80
    s_waitcnt lgkmcnt(0)
    v_max3_f32 v120, v112, v114, v116
    v_max_f32 v120, v120, v118
    v_sub_f32 v112, v112, v120
    v_sub_f32 v114, v114, v120
    v_sub_f32 v116, v116, v120
    v_sub_f32 v118, v118, v120
    v_mul_f32 v112, s58, v112
    v_mul_f32 v114, s58, v114
    v_mul_f32 v116, s58, v116
    v_mul_f32 v118, s58, v118
    v_exp_f32 v112, v112
    v_exp_f32 v114, v114
    v_exp_f32 v116, v116
    v_exp_f32 v118, v118
    v_mov_b32 v121, s44
    v_mul_f32 v122, v112, v113
    v_fmac_f32 v122, v114, v115
    v_fmac_f32 v122, v116, v117
    v_fmac_f32 v122, v118, v119
    v_mov_b32 v123, s44
    s_lshl_b32 s54, s46, 3
    s_add_u32 s54, s54, s47
    s_lshl_b32 s54, s54, 11
    s_add_u32 s54, s54, 720896
    s_mov_b64 exec, 1
    s_cmp_eq_u32 s74, 1
    s_cbranch_scc0 Lslow_5
    buffer_store_dwordx4 v[120:123], v13, s[32:35], s54 offen offset:1536
    s_branch Lpub_6
Lslow_5:
    buffer_store_dwordx4 v[120:123], v13, s[32:35], s54 offen offset:1536 sc1
Lpub_6:
    s_mov_b64 exec, -1
L_kprep:
    v_mov_b32 v143, 1
    s_sub_u32 s54, s49, 2
    s_and_b32 s64, s54, 1
    s_lshr_b32 s54, s54, 1
    s_mul_i32 s55, s48, 12
    s_add_u32 s55, s55, s54
    s_mul_i32 s56, s48, 3
    s_add_u32 s56, s56, s54
    s_sub_u32 s56, s56, 12
    s_add_u32 s57, s56, 96
    s_cmp_lt_u32 s54, 12
    s_cselect_b32 s65, s55, s56
    s_cselect_b32 s66, s55, s57
    s_cselect_b32 s36, s12, s20
    s_cselect_b32 s37, s13, s21
    s_mov_b32 s38, 1966080
    s_cselect_b32 s38, 7864320, s38
    s_mul_i32 s70, s65, 81920
    s_mul_i32 s55, s64, 640
    s_add_u32 s70, s70, s55
    s_lshl_b32 s55, s53, 7
    s_add_u32 s70, s70, s55
    s_mul_i32 s67, s66, 5120
    s_mul_i32 s68, s64, 2560
    s_add_u32 s67, s67, s68
    s_lshl_b32 s68, s53, 9
    s_add_u32 s67, s67, s68
    s_add_u32 s67, s67, 65536
    v_mul_u32_u24 v11, 1280, v2
    v_add_u32 v11, v11, v12
    v_mul_u32_u24 v10, 48, v2
    v_bfe_u32 v15, v1, 4, 1
    v_lshlrev_b32 v15, 8, v15
    v_add_u32 v15, v15, v12
    v_lshrrev_b32 v8, 5, v1
    v_lshl_add_u32 v15, v8, 7, v15
    s_mov_b32 s72, 0x00ff00ff
    s_mov_b32 s73, 0x00ff00ff
    v_mov_b32 v109, s44
    v_mov_b32 v111, s44
    s_waitcnt lgkmcnt(0)
    s_barrier
    s_cmp_lt_u32 s49, 2
    s_cbranch_scc1 L_now2
    s_add_u32 s71, s70, 0
    buffer_load_dwordx4 v[16:19], v11, s[36:39], s71 offen nt
    s_add_u32 s71, s70, 20480
    buffer_load_dwordx4 v[20:23], v11, s[36:39], s71 offen nt
    s_add_u32 s71, s70, 10240
    buffer_load_dwordx4 v[24:27], v11, s[36:39], s71 offen nt
    s_add_u32 s71, s70, 30720
    buffer_load_dwordx4 v[28:31], v11, s[36:39], s71 offen nt
L_now2:
    s_cmp_lg_u32 s53, 0
    s_cbranch_scc1 L_noml
L_noml:
    s_cmp_lt_u32 s49, 2
    s_cbranch_scc1 L_done
    s_mov_b32 s51, 160000
Lspin_7:
    ds_read_b32 v142, v13 offset:8
    s_waitcnt lgkmcnt(0)
    v_readfirstlane_b32 s52, v142
    s_cmp_ge_u32 s52, 4
    s_cbranch_scc1 Lspinok_8
    s_sleep 1
    s_sub_u32 s51, s51, 1
    s_cbranch_scc0 Lspin_7
Lspinok_8:
    s_add_u32 s71, s70, 40960
    buffer_load_dwordx4 v[32:35], v11, s[36:39], s71 offen nt
    s_add_u32 s71, s70, 61440
    buffer_load_dwordx4 v[36:39], v11, s[36:39], s71 offen nt
    s_add_u32 s71, s70, 51200
    buffer_load_dwordx4 v[40:43], v11, s[36:39], s71 offen nt
    s_add_u32 s71, s70, 71680
    buffer_load_dwordx4 v[44:47], v11, s[36:39], s71 offen nt
    s_mov_b32 s51, 160000
Lspin_9:
    ds_read_b32 v142, v13 offset:4
    s_waitcnt lgkmcnt(0)
    v_readfirstlane_b32 s52, v142
    s_cmp_ge_u32 s52, 1
    s_cbranch_scc1 Lspinok_10
    s_sleep 1
    s_sub_u32 s51, s51, 1
    s_cbranch_scc0 Lspin_9
Lspinok_10:
    ds_read_b128 v[124:127], v10 offset:2048
    ds_read_b128 v[128:131], v10 offset:2064
    s_waitcnt lgkmcnt(0)
    v_and_b32 v48, v124, v4
    v_and_b32 v49, v124, v5
    v_and_b32 v50, v124, v6
    v_and_b32 v51, v124, v7
    v_and_b32 v52, v125, v4
    v_and_b32 v53, v125, v5
    v_and_b32 v54, v125, v6
    v_and_b32 v55, v125, v7
    v_and_b32 v56, v126, v4
    v_and_b32 v57, v126, v5
    v_and_b32 v58, v126, v6
    v_and_b32 v59, v126, v7
    v_and_b32 v60, v127, v4
    v_and_b32 v61, v127, v5
    v_and_b32 v62, v127, v6
    v_and_b32 v63, v127, v7
    v_and_b32 v64, v128, v4
    v_and_b32 v65, v128, v5
    v_and_b32 v66, v128, v6
    v_and_b32 v67, v128, v7
    v_and_b32 v68, v129, v4
    v_and_b32 v69, v129, v5
    v_and_b32 v70, v129, v6
    v_and_b32 v71, v129, v7
    v_and_b32 v72, v130, v4
    v_and_b32 v73, v130, v5
    v_and_b32 v74, v130, v6
    v_and_b32 v75, v130, v7
    v_and_b32 v76, v131, v4
    v_and_b32 v77, v131, v5
    v_and_b32 v78, v131, v6
    v_and_b32 v79, v131, v7
    s_waitcnt vmcnt(7)
    v_mfma_f32_16x16x32_bf16 v[104:107], v[16:19], v[48:51], 0
    s_waitcnt vmcnt(6)
    v_mfma_f32_16x16x32_bf16 v[104:107], v[20:23], v[52:55], v[104:107]
    s_waitcnt vmcnt(5)
    v_mfma_f32_16x16x32_bf16 v[104:107], v[24:27], v[56:59], v[104:107]
    s_waitcnt vmcnt(4)
    v_mfma_f32_16x16x32_bf16 v[104:107], v[28:31], v[60:63], v[104:107]
    s_waitcnt vmcnt(3)
    v_mfma_f32_16x16x32_bf16 v[104:107], v[32:35], v[64:67], v[104:107]
    s_waitcnt vmcnt(2)
    v_mfma_f32_16x16x32_bf16 v[104:107], v[36:39], v[68:71], v[104:107]
    s_waitcnt vmcnt(1)
    v_mfma_f32_16x16x32_bf16 v[104:107], v[40:43], v[72:75], v[104:107]
    s_waitcnt vmcnt(0)
    v_mfma_f32_16x16x32_bf16 v[104:107], v[44:47], v[76:79], v[104:107]
    s_nop 7
    v_permlane32_swap_b32 v104, v105
    v_permlane32_swap_b32 v106, v107
    s_nop 1
    v_add_f32_dpp v108, v105, v104 row_ror:8 row_mask:0xf bank_mask:0xf
    v_add_f32_dpp v110, v107, v106 row_ror:8 row_mask:0xf bank_mask:0xf
    s_mov_b64 exec, s[72:73]
    buffer_store_dwordx4 v[108:111], v15, s[32:35], s67 offen sc1
    s_mov_b64 exec, 1
    s_waitcnt vmcnt(0)
    ds_add_u32 v13, v143 offset:12
    s_mov_b64 exec, -1
    s_branch L_done
L_vwave:
    s_setprio 3
    s_load_dword s45, s[26:27], 0
    s_mov_b32 s32, s26
    s_mov_b32 s33, s27
    s_mov_b32 s28, s8
    s_mov_b32 s29, s9
    s_mov_b32 s59, 0xffff0000
    s_cmp_ge_u32 s49, 30
    s_cbranch_scc1 L_vskip0
    v_and_b32 v8, 1, v3
    v_lshlrev_b32 v8, 4, v8
    v_mov_b32 v9, 0xffff
    v_lshlrev_b32 v9, v8, v9
    v_lshrrev_b32 v8, 1, v3
    v_cmp_eq_u32 vcc, 0, v8
    s_nop 1
    v_cndmask_b32 v4, 0, v9, vcc
    v_cmp_eq_u32 vcc, 1, v8
    s_nop 1
    v_cndmask_b32 v5, 0, v9, vcc
    v_cmp_eq_u32 vcc, 2, v8
    s_nop 1
    v_cndmask_b32 v6, 0, v9, vcc
    v_cmp_eq_u32 vcc, 3, v8
    s_nop 1
    v_cndmask_b32 v7, 0, v9, vcc
    s_waitcnt vmcnt(16)
    v_lshlrev_b32 v100, 16, v80
    v_and_b32 v101, s59, v80
    v_lshlrev_b32 v102, 16, v81
    v_and_b32 v103, s59, v81
    v_lshlrev_b32 v104, 16, v82
    v_and_b32 v105, s59, v82
    v_lshlrev_b32 v106, 16, v83
    v_and_b32 v107, s59, v83
    v_lshlrev_b32 v108, 16, v84
    v_and_b32 v109, s59, v84
    v_add_f32 v110, v100, v101
    v_add_f32 v110, v110, v102
    v_add_f32 v110, v110, v103
    v_add_f32 v110, v110, v104
    v_add_f32 v110, v110, v105
    v_add_f32 v110, v110, v106
    v_add_f32 v110, v110, v107
    v_add_f32 v110, v110, v108
    v_add_f32 v110, v110, v109
    s_nop 1
    v_add_f32_dpp v110, v110, v110 quad_perm:[1,0,3,2] row_mask:0xf bank_mask:0xf
    s_nop 1
    v_add_f32_dpp v110, v110, v110 quad_perm:[2,3,0,1] row_mask:0xf bank_mask:0xf
    s_nop 1
    v_add_f32_dpp v110, v110, v110 row_half_mirror row_mask:0xf bank_mask:0xf
    s_nop 1
    v_add_f32_dpp v110, v110, v110 row_ror:8 row_mask:0xf bank_mask:0xf
    v_mov_b32 v112, v110
    s_nop 1
    v_permlane16_swap_b32 v110, v112
    s_nop 0
    v_add_f32 v110, v110, v112
    v_mov_b32 v112, v110
    s_nop 1
    v_permlane32_swap_b32 v110, v112
    s_nop 0
    v_add_f32 v110, v110, v112
    v_mul_f32 v110, 0x3acccccd, v110
    v_sub_f32 v100, v100, v110
    v_sub_f32 v101, v101, v110
    v_sub_f32 v102, v102, v110
    v_sub_f32 v103, v103, v110
    v_sub_f32 v104, v104, v110
    v_sub_f32 v105, v105, v110
    v_sub_f32 v106, v106, v110
    v_sub_f32 v107, v107, v110
    v_sub_f32 v108, v108, v110
    v_sub_f32 v109, v109, v110
    v_mul_f32 v111, v100, v100
    v_fmac_f32 v111, v101, v101
    v_fmac_f32 v111, v102, v102
    v_fmac_f32 v111, v103, v103
    v_fmac_f32 v111, v104, v104
    v_fmac_f32 v111, v105, v105
    v_fmac_f32 v111, v106, v106
    v_fmac_f32 v111, v107, v107
    v_fmac_f32 v111, v108, v108
    v_fmac_f32 v111, v109, v109
    s_nop 1
    v_add_f32_dpp v111, v111, v111 quad_perm:[1,0,3,2] row_mask:0xf bank_mask:0xf
    s_nop 1
    v_add_f32_dpp v111, v111, v111 quad_perm:[2,3,0,1] row_mask:0xf bank_mask:0xf
    s_nop 1
    v_add_f32_dpp v111, v111, v111 row_half_mirror row_mask:0xf bank_mask:0xf
    s_nop 1
    v_add_f32_dpp v111, v111, v111 row_ror:8 row_mask:0xf bank_mask:0xf
    v_mov_b32 v112, v111
    s_nop 1
    v_permlane16_swap_b32 v111, v112
    s_nop 0
    v_add_f32 v111, v111, v112
    v_mov_b32 v112, v111
    s_nop 1
    v_permlane32_swap_b32 v111, v112
    s_nop 0
    v_add_f32 v111, v111, v112
    v_mul_f32 v111, 0x3acccccd, v111
    v_cvt_pk_bf16_f32 v112, v110, v111
    v_lshlrev_b32 v110, 16, v112
    v_and_b32 v111, s59, v112
    v_add_f32 v111, 0x3727c5ac, v111
    v_cvt_pk_bf16_f32 v111, v111, v111
    v_lshlrev_b32 v111, 16, v111
    v_sqrt_f32 v111, v111
    s_nop 0
    v_cvt_pk_bf16_f32 v111, v111, v111
    v_lshlrev_b32 v111, 16, v111
    v_rcp_f32 v113, v111
    v_lshlrev_b32 v100, 16, v88
    v_and_b32 v101, s59, v88
    v_sub_f32 v100, v100, v110
    v_sub_f32 v101, v101, v110
    v_cvt_pk_bf16_f32 v102, v100, v101
    v_lshlrev_b32 v100, 16, v102
    v_and_b32 v101, s59, v102
    v_mul_f32 v103, v100, v113
    v_fma_f32 v100, -v103, v111, v100
    v_fmac_f32 v103, v100, v113
    v_cvt_pk_bf16_f32 v114, v103, v103
    v_mul_f32 v104, v101, v113
    v_fma_f32 v101, -v104, v111, v101
    v_fmac_f32 v104, v101, v113
    v_cvt_pk_bf16_f32 v115, v104, v104
    v_and_b32 v148, v114, v4
    v_and_b32 v149, v114, v5
    v_and_b32 v150, v114, v6
    v_and_b32 v151, v114, v7
    v_and_b32 v152, v115, v4
    v_and_b32 v153, v115, v5
    v_and_b32 v154, v115, v6
    v_and_b32 v155, v115, v7
    s_waitcnt vmcnt(15)
    v_mfma_f32_16x16x32_bf16 v[144:147], v[16:19], v[148:151], 0
    v_lshlrev_b32 v100, 16, v89
    v_and_b32 v101, s59, v89
    v_sub_f32 v100, v100, v110
    v_sub_f32 v101, v101, v110
    v_cvt_pk_bf16_f32 v102, v100, v101
    v_lshlrev_b32 v100, 16, v102
    v_and_b32 v101, s59, v102
    v_mul_f32 v103, v100, v113
    v_fma_f32 v100, -v103, v111, v100
    v_fmac_f32 v103, v100, v113
    v_cvt_pk_bf16_f32 v116, v103, v103
    v_mul_f32 v104, v101, v113
    v_fma_f32 v101, -v104, v111, v101
    v_fmac_f32 v104, v101, v113
    v_cvt_pk_bf16_f32 v117, v104, v104
    v_and_b32 v148, v116, v4
    v_and_b32 v149, v116, v5
    v_and_b32 v150, v116, v6
    v_and_b32 v151, v116, v7
    s_waitcnt vmcnt(14)
    v_mfma_f32_16x16x32_bf16 v[144:147], v[20:23], v[152:155], v[144:147]
    v_and_b32 v152, v117, v4
    v_and_b32 v153, v117, v5
    v_and_b32 v154, v117, v6
    v_and_b32 v155, v117, v7
    s_waitcnt vmcnt(13)
    v_mfma_f32_16x16x32_bf16 v[144:147], v[24:27], v[148:151], v[144:147]
    v_lshlrev_b32 v100, 16, v90
    v_and_b32 v101, s59, v90
    v_sub_f32 v100, v100, v110
    v_sub_f32 v101, v101, v110
    v_cvt_pk_bf16_f32 v102, v100, v101
    v_lshlrev_b32 v100, 16, v102
    v_and_b32 v101, s59, v102
    v_mul_f32 v103, v100, v113
    v_fma_f32 v100, -v103, v111, v100
    v_fmac_f32 v103, v100, v113
    v_cvt_pk_bf16_f32 v118, v103, v103
    v_mul_f32 v104, v101, v113
    v_fma_f32 v101, -v104, v111, v101
    v_fmac_f32 v104, v101, v113
    v_cvt_pk_bf16_f32 v119, v104, v104
    v_and_b32 v148, v118, v4
    v_and_b32 v149, v118, v5
    v_and_b32 v150, v118, v6
    v_and_b32 v151, v118, v7
    s_waitcnt vmcnt(12)
    v_mfma_f32_16x16x32_bf16 v[144:147], v[28:31], v[152:155], v[144:147]
    v_and_b32 v152, v119, v4
    v_and_b32 v153, v119, v5
    v_and_b32 v154, v119, v6
    v_and_b32 v155, v119, v7
    s_waitcnt vmcnt(11)
    v_mfma_f32_16x16x32_bf16 v[144:147], v[32:35], v[148:151], v[144:147]
    v_lshlrev_b32 v100, 16, v91
    v_and_b32 v101, s59, v91
    v_sub_f32 v100, v100, v110
    v_sub_f32 v101, v101, v110
    v_cvt_pk_bf16_f32 v102, v100, v101
    v_lshlrev_b32 v100, 16, v102
    v_and_b32 v101, s59, v102
    v_mul_f32 v103, v100, v113
    v_fma_f32 v100, -v103, v111, v100
    v_fmac_f32 v103, v100, v113
    v_cvt_pk_bf16_f32 v120, v103, v103
    v_mul_f32 v104, v101, v113
    v_fma_f32 v101, -v104, v111, v101
    v_fmac_f32 v104, v101, v113
    v_cvt_pk_bf16_f32 v121, v104, v104
    v_and_b32 v148, v120, v4
    v_and_b32 v149, v120, v5
    v_and_b32 v150, v120, v6
    v_and_b32 v151, v120, v7
    s_waitcnt vmcnt(10)
    v_mfma_f32_16x16x32_bf16 v[144:147], v[36:39], v[152:155], v[144:147]
    v_and_b32 v152, v121, v4
    v_and_b32 v153, v121, v5
    v_and_b32 v154, v121, v6
    v_and_b32 v155, v121, v7
    s_waitcnt vmcnt(9)
    v_mfma_f32_16x16x32_bf16 v[144:147], v[40:43], v[148:151], v[144:147]
    v_lshlrev_b32 v100, 16, v92
    v_and_b32 v101, s59, v92
    v_sub_f32 v100, v100, v110
    v_sub_f32 v101, v101, v110
    v_cvt_pk_bf16_f32 v102, v100, v101
    v_lshlrev_b32 v100, 16, v102
    v_and_b32 v101, s59, v102
    v_mul_f32 v103, v100, v113
    v_fma_f32 v100, -v103, v111, v100
    v_fmac_f32 v103, v100, v113
    v_cvt_pk_bf16_f32 v122, v103, v103
    v_mul_f32 v104, v101, v113
    v_fma_f32 v101, -v104, v111, v101
    v_fmac_f32 v104, v101, v113
    v_cvt_pk_bf16_f32 v123, v104, v104
    v_and_b32 v148, v122, v4
    v_and_b32 v149, v122, v5
    v_and_b32 v150, v122, v6
    v_and_b32 v151, v122, v7
    s_waitcnt vmcnt(8)
    v_mfma_f32_16x16x32_bf16 v[144:147], v[44:47], v[152:155], v[144:147]
    v_and_b32 v152, v123, v4
    v_and_b32 v153, v123, v5
    v_and_b32 v154, v123, v6
    v_and_b32 v155, v123, v7
    s_waitcnt vmcnt(7)
    v_mfma_f32_16x16x32_bf16 v[144:147], v[48:51], v[148:151], v[144:147]
    v_lshlrev_b32 v100, 16, v93
    v_and_b32 v101, s59, v93
    v_sub_f32 v100, v100, v110
    v_sub_f32 v101, v101, v110
    v_cvt_pk_bf16_f32 v102, v100, v101
    v_lshlrev_b32 v100, 16, v102
    v_and_b32 v101, s59, v102
    v_mul_f32 v103, v100, v113
    v_fma_f32 v100, -v103, v111, v100
    v_fmac_f32 v103, v100, v113
    v_cvt_pk_bf16_f32 v124, v103, v103
    v_mul_f32 v104, v101, v113
    v_fma_f32 v101, -v104, v111, v101
    v_fmac_f32 v104, v101, v113
    v_cvt_pk_bf16_f32 v125, v104, v104
    v_and_b32 v148, v124, v4
    v_and_b32 v149, v124, v5
    v_and_b32 v150, v124, v6
    v_and_b32 v151, v124, v7
    s_waitcnt vmcnt(6)
    v_mfma_f32_16x16x32_bf16 v[144:147], v[52:55], v[152:155], v[144:147]
    v_and_b32 v152, v125, v4
    v_and_b32 v153, v125, v5
    v_and_b32 v154, v125, v6
    v_and_b32 v155, v125, v7
    s_waitcnt vmcnt(5)
    v_mfma_f32_16x16x32_bf16 v[144:147], v[56:59], v[148:151], v[144:147]
    v_lshlrev_b32 v100, 16, v94
    v_and_b32 v101, s59, v94
    v_sub_f32 v100, v100, v110
    v_sub_f32 v101, v101, v110
    v_cvt_pk_bf16_f32 v102, v100, v101
    v_lshlrev_b32 v100, 16, v102
    v_and_b32 v101, s59, v102
    v_mul_f32 v103, v100, v113
    v_fma_f32 v100, -v103, v111, v100
    v_fmac_f32 v103, v100, v113
    v_cvt_pk_bf16_f32 v126, v103, v103
    v_mul_f32 v104, v101, v113
    v_fma_f32 v101, -v104, v111, v101
    v_fmac_f32 v104, v101, v113
    v_cvt_pk_bf16_f32 v127, v104, v104
    v_and_b32 v148, v126, v4
    v_and_b32 v149, v126, v5
    v_and_b32 v150, v126, v6
    v_and_b32 v151, v126, v7
    s_waitcnt vmcnt(4)
    v_mfma_f32_16x16x32_bf16 v[144:147], v[60:63], v[152:155], v[144:147]
    v_and_b32 v152, v127, v4
    v_and_b32 v153, v127, v5
    v_and_b32 v154, v127, v6
    v_and_b32 v155, v127, v7
    s_waitcnt vmcnt(3)
    v_mfma_f32_16x16x32_bf16 v[144:147], v[64:67], v[148:151], v[144:147]
    v_lshlrev_b32 v100, 16, v95
    v_and_b32 v101, s59, v95
    v_sub_f32 v100, v100, v110
    v_sub_f32 v101, v101, v110
    v_cvt_pk_bf16_f32 v102, v100, v101
    v_lshlrev_b32 v100, 16, v102
    v_and_b32 v101, s59, v102
    v_mul_f32 v103, v100, v113
    v_fma_f32 v100, -v103, v111, v100
    v_fmac_f32 v103, v100, v113
    v_cvt_pk_bf16_f32 v128, v103, v103
    v_mul_f32 v104, v101, v113
    v_fma_f32 v101, -v104, v111, v101
    v_fmac_f32 v104, v101, v113
    v_cvt_pk_bf16_f32 v129, v104, v104
    v_and_b32 v148, v128, v4
    v_and_b32 v149, v128, v5
    v_and_b32 v150, v128, v6
    v_and_b32 v151, v128, v7
    s_waitcnt vmcnt(2)
    v_mfma_f32_16x16x32_bf16 v[144:147], v[68:71], v[152:155], v[144:147]
    v_and_b32 v152, v129, v4
    v_and_b32 v153, v129, v5
    v_and_b32 v154, v129, v6
    v_and_b32 v155, v129, v7
    s_waitcnt vmcnt(1)
    v_mfma_f32_16x16x32_bf16 v[144:147], v[72:75], v[148:151], v[144:147]
    s_nop 1
    s_waitcnt vmcnt(0)
    v_mfma_f32_16x16x32_bf16 v[144:147], v[76:79], v[152:155], v[144:147]
    s_nop 7
    v_permlane32_swap_b32 v144, v145
    v_permlane32_swap_b32 v146, v147
    s_nop 1
    v_add_f32_dpp v204, v145, v144 row_ror:8 row_mask:0xf bank_mask:0xf
    v_add_f32_dpp v206, v147, v146 row_ror:8 row_mask:0xf bank_mask:0xf
    s_waitcnt lgkmcnt(0)
    s_mul_i32 s44, s45, 0x9E3779B1
    s_add_u32 s44, s44, 0x7F4A7C15
    v_bfe_u32 v15, v1, 4, 1
    v_lshlrev_b32 v15, 8, v15
    v_add_u32 v15, v15, v12
    v_lshrrev_b32 v8, 5, v1
    v_lshl_add_u32 v15, v8, 7, v15
    s_mov_b32 s72, 0x00ff00ff
    s_mov_b32 s73, 0x00ff00ff
    v_mov_b32 v205, s44
    v_mov_b32 v207, s44
    s_lshl_b32 s54, s54, 3
    s_add_u32 s54, s54, s55
    s_lshl_b32 s54, s54, 11
    s_lshl_b32 s55, s3, 9
    s_add_u32 s54, s54, s55
    s_add_u32 s78, s54, 1245184
    s_mov_b64 exec, s[72:73]
    buffer_store_dwordx4 v[204:207], v15, s[32:35], s78 offen
    s_mov_b64 exec, -1
    s_branch L_vload
L_vskip0:
    v_and_b32 v8, 1, v3
    v_lshlrev_b32 v8, 4, v8
    v_mov_b32 v9, 0xffff
    v_lshlrev_b32 v9, v8, v9
    v_lshrrev_b32 v8, 1, v3
    v_cmp_eq_u32 vcc, 0, v8
    s_nop 1
    v_cndmask_b32 v4, 0, v9, vcc
    v_cmp_eq_u32 vcc, 1, v8
    s_nop 1
    v_cndmask_b32 v5, 0, v9, vcc
    v_cmp_eq_u32 vcc, 2, v8
    s_nop 1
    v_cndmask_b32 v6, 0, v9, vcc
    v_cmp_eq_u32 vcc, 3, v8
    s_nop 1
    v_cndmask_b32 v7, 0, v9, vcc
    s_waitcnt lgkmcnt(0)
    s_mul_i32 s44, s45, 0x9E3779B1
    s_add_u32 s44, s44, 0x7F4A7C15
    v_bfe_u32 v15, v1, 4, 1
    v_lshlrev_b32 v15, 8, v15
    v_add_u32 v15, v15, v12
    v_lshrrev_b32 v8, 5, v1
    v_lshl_add_u32 v15, v8, 7, v15
    s_mov_b32 s72, 0x00ff00ff
    s_mov_b32 s73, 0x00ff00ff
    v_mov_b32 v205, s44
    v_mov_b32 v207, s44
L_vload:
    s_setprio 0
    v_mul_u32_u24 v14, 144, v2
    s_lshl_b32 s54, s46, 3
    s_add_u32 s54, s54, s47
    s_lshl_b32 s54, s54, 11
    s_lshl_b32 s55, s3, 9
    s_add_u32 s54, s54, s55
    s_add_u32 s79, s54, 720896
    s_mov_b32 s58, 0x3fb8aa3b
    v_mov_b32 v198, 1
    s_sub_u32 s54, s49, 2
    s_and_b32 s64, s54, 1
    s_lshr_b32 s54, s54, 1
    s_mul_i32 s55, s48, 12
    s_add_u32 s55, s55, s54
    s_mul_i32 s56, s48, 3
    s_add_u32 s56, s56, s54
    s_sub_u32 s56, s56, 12
    s_add_u32 s57, s56, 96
    s_cmp_lt_u32 s54, 12
    s_cselect_b32 s65, s55, s56
    s_cselect_b32 s66, s55, s57
    s_mov_b32 s69, 1769472
    s_cselect_b32 s69, 720896, s69
    s_mul_i32 s54, s65, 171
    s_lshr_b32 s54, s54, 9
    s_mul_i32 s55, s54, 3
    s_sub_u32 s55, s65, s55
    s_lshl_b32 s55, s55, 9
    s_lshl_b32 s54, s54, 14
    s_add_u32 s60, s54, s69
    s_add_u32 s61, s60, s55
    v_mul_u32_u24 v10, 48, v2
    v_lshlrev_b32 v202, 11, v3
    v_lshl_add_u32 v203, v2, 4, v202
    s_lshl_b32 s52, s3, 7
    s_add_u32 s52, s52, s50
    buffer_load_dwordx4 v[16:19], v11, s[28:31], s52 offen nt
    s_add_u32 s52, s52, 24576
    buffer_load_dwordx4 v[20:23], v11, s[28:31], s52 offen nt
    s_add_u32 s52, s52, 24576
    buffer_load_dwordx4 v[24:27], v11, s[28:31], s52 offen nt
    s_add_u32 s52, s52, 24576
    buffer_load_dwordx4 v[28:31], v11, s[28:31], s52 offen nt
    s_add_u32 s52, s52, 24576
    buffer_load_dwordx4 v[32:35], v11, s[28:31], s52 offen nt
    s_add_u32 s52, s52, 24576
    buffer_load_dwordx4 v[36:39], v11, s[28:31], s52 offen nt
    s_add_u32 s52, s52, 24576
    buffer_load_dwordx4 v[40:43], v11, s[28:31], s52 offen nt
    s_add_u32 s52, s52, 24576
    buffer_load_dwordx4 v[44:47], v11, s[28:31], s52 offen nt
    s_add_u32 s52, s52, 24576
    buffer_load_dwordx4 v[48:51], v11, s[28:31], s52 offen nt
    s_add_u32 s52, s52, 24576
    buffer_load_dwordx4 v[52:55], v11, s[28:31], s52 offen nt
    s_add_u32 s52, s52, 24576
    v_and_b32 v8, 31, v1
    v_lshlrev_b32 v8, 3, v8
    buffer_load_dwordx2 v[200:201], v8, s[32:35], s77 offen sc1
    buffer_load_dwordx4 v[56:59], v11, s[28:31], s52 offen nt
    s_add_u32 s52, s52, 24576
    buffer_load_dwordx4 v[60:63], v11, s[28:31], s52 offen nt
    s_add_u32 s52, s52, 24576
    buffer_load_dwordx4 v[64:67], v11, s[28:31], s52 offen nt
    s_add_u32 s52, s52, 24576
    buffer_load_dwordx4 v[68:71], v11, s[28:31], s52 offen nt
    s_add_u32 s52, s52, 24576
    buffer_load_dwordx4 v[72:75], v11, s[28:31], s52 offen nt
    s_add_u32 s52, s52, 24576
    buffer_load_dwordx4 v[76:79], v11, s[28:31], s52 offen nt
    s_add_u32 s52, s52, 24576
    buffer_load_dwordx4 v[80:83], v11, s[28:31], s52 offen nt
    s_add_u32 s52, s52, 24576
    buffer_load_dwordx4 v[84:87], v11, s[28:31], s52 offen nt
    s_add_u32 s52, s52, 24576
    s_waitcnt vmcnt(8)
    v_xor_b32 v8, s44, v201
    v_bitop3_b32 v8, v200, s75, v8 bitop3:0xbe
    v_cmp_ne_u32 vcc, 0, v8
    s_cmp_eq_u64 vcc, 0
    s_cselect_b32 s74, 1, 0
    s_cmp_eq_u32 s74, 1
    s_cbranch_scc1 Lrep_11
    s_cmp_ge_u32 s49, 30
    s_cbranch_scc1 Lrep_11
    s_mov_b64 exec, s[72:73]
    buffer_store_dwordx4 v[204:207], v15, s[32:35], s78 offen sc1
    s_mov_b64 exec, -1
Lrep_11:
    buffer_load_dwordx4 v[88:91], v11, s[28:31], s52 offen nt
    s_add_u32 s52, s52, 24576
    buffer_load_dwordx4 v[92:95], v11, s[28:31], s52 offen nt
    s_add_u32 s52, s52, 24576
    buffer_load_dwordx4 v[96:99], v11, s[28:31], s52 offen nt
    s_add_u32 s52, s52, 24576
    buffer_load_dwordx4 v[100:103], v11, s[28:31], s52 offen nt
    s_add_u32 s52, s52, 24576
    buffer_load_dwordx4 v[104:107], v11, s[28:31], s52 offen nt
    s_add_u32 s52, s52, 24576
    buffer_load_dwordx4 v[108:111], v11, s[28:31], s52 offen nt
    s_add_u32 s52, s52, 24576
    buffer_load_dwordx4 v[112:115], v11, s[28:31], s52 offen nt
    s_add_u32 s52, s52, 24576
    buffer_load_dwordx4 v[116:119], v11, s[28:31], s52 offen nt
    s_add_u32 s52, s52, 24576
    buffer_load_dwordx4 v[120:123], v11, s[28:31], s52 offen nt
    s_add_u32 s52, s52, 24576
    buffer_load_dwordx4 v[124:127], v11, s[28:31], s52 offen nt
    s_add_u32 s52, s52, 24576
    buffer_load_dwordx4 v[128:131], v11, s[28:31], s52 offen nt
    s_add_u32 s52, s52, 24576
    buffer_load_dwordx4 v[132:135], v11, s[28:31], s52 offen nt
    s_add_u32 s52, s52, 24576
    buffer_load_dwordx4 v[136:139], v11, s[28:31], s52 offen nt
    s_add_u32 s52, s52, 24576
    buffer_load_dwordx4 v[140:143], v11, s[28:31], s52 offen nt
    s_barrier
    s_setprio 3
    ds_read_b128 v[188:191], v13 offset:64
    ds_read_b128 v[192:195], v13 offset:80
    ds_read_b128 v[156:159], v14 offset:512
    ds_read_b128 v[160:163], v14 offset:528
    ds_read_b128 v[164:167], v14 offset:544
    ds_read_b128 v[168:171], v14 offset:560
    ds_read_b128 v[172:175], v14 offset:576
    ds_read_b128 v[176:179], v14 offset:592
    ds_read_b128 v[180:183], v14 offset:608
    ds_read_b128 v[184:187], v14 offset:624
    s_waitcnt lgkmcnt(0)
    v_max3_f32 v196, v188, v190, v192
    v_max_f32 v196, v196, v194
    v_sub_f32 v188, v188, v196
    v_sub_f32 v190, v190, v196
    v_sub_f32 v192, v192, v196
    v_sub_f32 v194, v194, v196
    v_mul_f32 v188, s58, v188
    v_mul_f32 v190, s58, v190
    v_mul_f32 v192, s58, v192
    v_mul_f32 v194, s58, v194
    v_exp_f32 v188, v188
    v_exp_f32 v190, v190
    v_exp_f32 v192, v192
    v_exp_f32 v194, v194
    s_nop 0
    v_mul_f32 v156, v156, v188
    v_cvt_pk_bf16_f32 v156, v156, v156
    v_and_b32 v148, v156, v4
    v_and_b32 v149, v156, v5
    v_and_b32 v150, v156, v6
    v_and_b32 v151, v156, v7
    v_mul_f32 v164, v164, v190
    v_cvt_pk_bf16_f32 v164, v164, v164
    v_and_b32 v152, v164, v4
    v_and_b32 v153, v164, v5
    v_and_b32 v154, v164, v6
    v_and_b32 v155, v164, v7
    s_waitcnt vmcnt(31)
    v_mfma_f32_16x16x32_bf16 v[144:147], v[16:19], v[148:151], 0
    v_mul_f32 v172, v172, v192
    v_cvt_pk_bf16_f32 v172, v172, v172
    v_and_b32 v148, v172, v4
    v_and_b32 v149, v172, v5
    v_and_b32 v150, v172, v6
    v_and_b32 v151, v172, v7
    s_waitcnt vmcnt(30)
    v_mfma_f32_16x16x32_bf16 v[144:147], v[20:23], v[152:155], v[144:147]
    v_mul_f32 v180, v180, v194
    v_cvt_pk_bf16_f32 v180, v180, v180
    v_and_b32 v152, v180, v4
    v_and_b32 v153, v180, v5
    v_and_b32 v154, v180, v6
    v_and_b32 v155, v180, v7
    s_waitcnt vmcnt(29)
    v_mfma_f32_16x16x32_bf16 v[144:147], v[24:27], v[148:151], v[144:147]
    v_mul_f32 v157, v157, v188
    v_cvt_pk_bf16_f32 v157, v157, v157
    v_and_b32 v148, v157, v4
    v_and_b32 v149, v157, v5
    v_and_b32 v150, v157, v6
    v_and_b32 v151, v157, v7
    s_waitcnt vmcnt(28)
    v_mfma_f32_16x16x32_bf16 v[144:147], v[28:31], v[152:155], v[144:147]
    v_mul_f32 v165, v165, v190
    v_cvt_pk_bf16_f32 v165, v165, v165
    v_and_b32 v152, v165, v4
    v_and_b32 v153, v165, v5
    v_and_b32 v154, v165, v6
    v_and_b32 v155, v165, v7
    s_waitcnt vmcnt(27)
    v_mfma_f32_16x16x32_bf16 v[144:147], v[32:35], v[148:151], v[144:147]
    v_mul_f32 v173, v173, v192
    v_cvt_pk_bf16_f32 v173, v173, v173
    v_and_b32 v148, v173, v4
    v_and_b32 v149, v173, v5
    v_and_b32 v150, v173, v6
    v_and_b32 v151, v173, v7
    s_waitcnt vmcnt(26)
    v_mfma_f32_16x16x32_bf16 v[144:147], v[36:39], v[152:155], v[144:147]
    v_mul_f32 v181, v181, v194
    v_cvt_pk_bf16_f32 v181, v181, v181
    v_and_b32 v152, v181, v4
    v_and_b32 v153, v181, v5
    v_and_b32 v154, v181, v6
    v_and_b32 v155, v181, v7
    s_waitcnt vmcnt(25)
    v_mfma_f32_16x16x32_bf16 v[144:147], v[40:43], v[148:151], v[144:147]
    v_mul_f32 v158, v158, v188
    v_cvt_pk_bf16_f32 v158, v158, v158
    v_and_b32 v148, v158, v4
    v_and_b32 v149, v158, v5
    v_and_b32 v150, v158, v6
    v_and_b32 v151, v158, v7
    s_waitcnt vmcnt(24)
    v_mfma_f32_16x16x32_bf16 v[144:147], v[44:47], v[152:155], v[144:147]
    v_mul_f32 v166, v166, v190
    v_cvt_pk_bf16_f32 v166, v166, v166
    v_and_b32 v152, v166, v4
    v_and_b32 v153, v166, v5
    v_and_b32 v154, v166, v6
    v_and_b32 v155, v166, v7
    s_waitcnt vmcnt(23)
    v_mfma_f32_16x16x32_bf16 v[144:147], v[48:51], v[148:151], v[144:147]
    v_mul_f32 v174, v174, v192
    v_cvt_pk_bf16_f32 v174, v174, v174
    v_and_b32 v148, v174, v4
    v_and_b32 v149, v174, v5
    v_and_b32 v150, v174, v6
    v_and_b32 v151, v174, v7
    s_waitcnt vmcnt(22)
    v_mfma_f32_16x16x32_bf16 v[144:147], v[52:55], v[152:155], v[144:147]
    v_mul_f32 v182, v182, v194
    v_cvt_pk_bf16_f32 v182, v182, v182
    v_and_b32 v152, v182, v4
    v_and_b32 v153, v182, v5
    v_and_b32 v154, v182, v6
    v_and_b32 v155, v182, v7
    s_waitcnt vmcnt(21)
    v_mfma_f32_16x16x32_bf16 v[144:147], v[56:59], v[148:151], v[144:147]
    v_mul_f32 v159, v159, v188
    v_cvt_pk_bf16_f32 v159, v159, v159
    v_and_b32 v148, v159, v4
    v_and_b32 v149, v159, v5
    v_and_b32 v150, v159, v6
    v_and_b32 v151, v159, v7
    s_waitcnt vmcnt(20)
    v_mfma_f32_16x16x32_bf16 v[144:147], v[60:63], v[152:155], v[144:147]
    v_mul_f32 v167, v167, v190
    v_cvt_pk_bf16_f32 v167, v167, v167
    v_and_b32 v152, v167, v4
    v_and_b32 v153, v167, v5
    v_and_b32 v154, v167, v6
    v_and_b32 v155, v167, v7
    s_waitcnt vmcnt(19)
    v_mfma_f32_16x16x32_bf16 v[144:147], v[64:67], v[148:151], v[144:147]
    v_mul_f32 v175, v175, v192
    v_cvt_pk_bf16_f32 v175, v175, v175
    v_and_b32 v148, v175, v4
    v_and_b32 v149, v175, v5
    v_and_b32 v150, v175, v6
    v_and_b32 v151, v175, v7
    s_waitcnt vmcnt(18)
    v_mfma_f32_16x16x32_bf16 v[144:147], v[68:71], v[152:155], v[144:147]
    v_mul_f32 v183, v183, v194
    v_cvt_pk_bf16_f32 v183, v183, v183
    v_and_b32 v152, v183, v4
    v_and_b32 v153, v183, v5
    v_and_b32 v154, v183, v6
    v_and_b32 v155, v183, v7
    s_waitcnt vmcnt(17)
    v_mfma_f32_16x16x32_bf16 v[144:147], v[72:75], v[148:151], v[144:147]
    v_mul_f32 v160, v160, v188
    v_cvt_pk_bf16_f32 v160, v160, v160
    v_and_b32 v148, v160, v4
    v_and_b32 v149, v160, v5
    v_and_b32 v150, v160, v6
    v_and_b32 v151, v160, v7
    s_waitcnt vmcnt(16)
    v_mfma_f32_16x16x32_bf16 v[144:147], v[76:79], v[152:155], v[144:147]
    v_mul_f32 v168, v168, v190
    v_cvt_pk_bf16_f32 v168, v168, v168
    v_and_b32 v152, v168, v4
    v_and_b32 v153, v168, v5
    v_and_b32 v154, v168, v6
    v_and_b32 v155, v168, v7
    s_waitcnt vmcnt(15)
    v_mfma_f32_16x16x32_bf16 v[144:147], v[80:83], v[148:151], v[144:147]
    v_mul_f32 v176, v176, v192
    v_cvt_pk_bf16_f32 v176, v176, v176
    v_and_b32 v148, v176, v4
    v_and_b32 v149, v176, v5
    v_and_b32 v150, v176, v6
    v_and_b32 v151, v176, v7
    s_waitcnt vmcnt(14)
    v_mfma_f32_16x16x32_bf16 v[144:147], v[84:87], v[152:155], v[144:147]
    v_mul_f32 v184, v184, v194
    v_cvt_pk_bf16_f32 v184, v184, v184
    v_and_b32 v152, v184, v4
    v_and_b32 v153, v184, v5
    v_and_b32 v154, v184, v6
    v_and_b32 v155, v184, v7
    s_waitcnt vmcnt(13)
    v_mfma_f32_16x16x32_bf16 v[144:147], v[88:91], v[148:151], v[144:147]
    v_mul_f32 v161, v161, v188
    v_cvt_pk_bf16_f32 v161, v161, v161
    v_and_b32 v148, v161, v4
    v_and_b32 v149, v161, v5
    v_and_b32 v150, v161, v6
    v_and_b32 v151, v161, v7
    s_waitcnt vmcnt(12)
    v_mfma_f32_16x16x32_bf16 v[144:147], v[92:95], v[152:155], v[144:147]
    v_mul_f32 v169, v169, v190
    v_cvt_pk_bf16_f32 v169, v169, v169
    v_and_b32 v152, v169, v4
    v_and_b32 v153, v169, v5
    v_and_b32 v154, v169, v6
    v_and_b32 v155, v169, v7
    s_waitcnt vmcnt(11)
    v_mfma_f32_16x16x32_bf16 v[144:147], v[96:99], v[148:151], v[144:147]
    v_mul_f32 v177, v177, v192
    v_cvt_pk_bf16_f32 v177, v177, v177
    v_and_b32 v148, v177, v4
    v_and_b32 v149, v177, v5
    v_and_b32 v150, v177, v6
    v_and_b32 v151, v177, v7
    s_waitcnt vmcnt(10)
    v_mfma_f32_16x16x32_bf16 v[144:147], v[100:103], v[152:155], v[144:147]
    v_mul_f32 v185, v185, v194
    v_cvt_pk_bf16_f32 v185, v185, v185
    v_and_b32 v152, v185, v4
    v_and_b32 v153, v185, v5
    v_and_b32 v154, v185, v6
    v_and_b32 v155, v185, v7
    s_waitcnt vmcnt(9)
    v_mfma_f32_16x16x32_bf16 v[144:147], v[104:107], v[148:151], v[144:147]
    v_mul_f32 v162, v162, v188
    v_cvt_pk_bf16_f32 v162, v162, v162
    v_and_b32 v148, v162, v4
    v_and_b32 v149, v162, v5
    v_and_b32 v150, v162, v6
    v_and_b32 v151, v162, v7
    s_waitcnt vmcnt(8)
    v_mfma_f32_16x16x32_bf16 v[144:147], v[108:111], v[152:155], v[144:147]
    v_mul_f32 v170, v170, v190
    v_cvt_pk_bf16_f32 v170, v170, v170
    v_and_b32 v152, v170, v4
    v_and_b32 v153, v170, v5
    v_and_b32 v154, v170, v6
    v_and_b32 v155, v170, v7
    s_waitcnt vmcnt(7)
    v_mfma_f32_16x16x32_bf16 v[144:147], v[112:115], v[148:151], v[144:147]
    v_mul_f32 v178, v178, v192
    v_cvt_pk_bf16_f32 v178, v178, v178
    v_and_b32 v148, v178, v4
    v_and_b32 v149, v178, v5
    v_and_b32 v150, v178, v6
    v_and_b32 v151, v178, v7
    s_waitcnt vmcnt(6)
    v_mfma_f32_16x16x32_bf16 v[144:147], v[116:119], v[152:155], v[144:147]
    v_mul_f32 v186, v186, v194
    v_cvt_pk_bf16_f32 v186, v186, v186
    v_and_b32 v152, v186, v4
    v_and_b32 v153, v186, v5
    v_and_b32 v154, v186, v6
    v_and_b32 v155, v186, v7
    s_waitcnt vmcnt(5)
    v_mfma_f32_16x16x32_bf16 v[144:147], v[120:123], v[148:151], v[144:147]
    v_mul_f32 v163, v163, v188
    v_cvt_pk_bf16_f32 v163, v163, v163
    v_and_b32 v148, v163, v4
    v_and_b32 v149, v163, v5
    v_and_b32 v150, v163, v6
    v_and_b32 v151, v163, v7
    s_waitcnt vmcnt(4)
    v_mfma_f32_16x16x32_bf16 v[144:147], v[124:127], v[152:155], v[144:147]
    v_mul_f32 v171, v171, v190
    v_cvt_pk_bf16_f32 v171, v171, v171
    v_and_b32 v152, v171, v4
    v_and_b32 v153, v171, v5
    v_and_b32 v154, v171, v6
    v_and_b32 v155, v171, v7
    s_waitcnt vmcnt(3)
    v_mfma_f32_16x16x32_bf16 v[144:147], v[128:131], v[148:151], v[144:147]
    v_mul_f32 v179, v179, v192
    v_cvt_pk_bf16_f32 v179, v179, v179
    v_and_b32 v148, v179, v4
    v_and_b32 v149, v179, v5
    v_and_b32 v150, v179, v6
    v_and_b32 v151, v179, v7
    s_waitcnt vmcnt(2)
    v_mfma_f32_16x16x32_bf16 v[144:147], v[132:135], v[152:155], v[144:147]
    v_mul_f32 v187, v187, v194
    v_cvt_pk_bf16_f32 v187, v187, v187
    v_and_b32 v152, v187, v4
    v_and_b32 v153, v187, v5
    v_and_b32 v154, v187, v6
    v_and_b32 v155, v187, v7
    s_waitcnt vmcnt(1)
    v_mfma_f32_16x16x32_bf16 v[144:147], v[136:139], v[148:151], v[144:147]
    s_nop 1
    s_waitcnt vmcnt(0)
    v_mfma_f32_16x16x32_bf16 v[144:147], v[140:143], v[152:155], v[144:147]
    s_nop 7
    v_permlane32_swap_b32 v144, v145
    v_permlane32_swap_b32 v146, v147
    s_nop 1
    v_add_f32_dpp v204, v145, v144 row_ror:8 row_mask:0xf bank_mask:0xf
    v_add_f32_dpp v206, v147, v146 row_ror:8 row_mask:0xf bank_mask:0xf
    s_mov_b64 exec, s[72:73]
    s_cmp_eq_u32 s74, 1
    s_cbranch_scc0 Lslow_12
    buffer_store_dwordx4 v[204:207], v15, s[32:35], s79 offen
    s_branch Lpub_13
Lslow_12:
    buffer_store_dwordx4 v[204:207], v15, s[32:35], s79 offen sc1
Lpub_13:
    s_mov_b64 exec, -1
    s_mov_b64 exec, 1
    ds_add_u32 v13, v198 offset:8
    s_mov_b64 exec, -1
    s_cmp_eq_u32 s3, 0
    s_cbranch_scc1 L_final
    s_cmp_lg_u32 s3, 1
    s_cbranch_scc1 L_done
    s_cmp_lt_u32 s49, 2
    s_cbranch_scc1 L_done
    s_cmp_ge_u32 s66, 96
    s_cbranch_scc1 L_cdn
    s_mov_b32 s51, 160000
Lspin_14:
    ds_read_b32 v188, v13 offset:8
    s_waitcnt lgkmcnt(0)
    v_readfirstlane_b32 s52, v188
    s_cmp_ge_u32 s52, 3
    s_cbranch_scc1 Lspinok_15
    s_sleep 1
    s_sub_u32 s51, s51, 1
    s_cbranch_scc0 Lspin_14
Lspinok_15:
    s_mov_b32 s51, 20000
    buffer_load_dwordx4 v[48:51], v202, s[32:35], s60 offen offset:1536 sc1
    buffer_load_dwordx4 v[16:19], v203, s[32:35], s61 offen offset:0 sc1
    buffer_load_dwordx4 v[20:23], v203, s[32:35], s61 offen offset:128 sc1
    buffer_load_dwordx4 v[24:27], v203, s[32:35], s61 offen offset:256 sc1
    buffer_load_dwordx4 v[28:31], v203, s[32:35], s61 offen offset:384 sc1
    s_mov_b64 exec, 1
    ds_add_u32 v13, v198 offset:8
    s_mov_b64 exec, -1
    s_branch L_c1chk
L_c1:
    buffer_load_dwordx4 v[48:51], v202, s[32:35], s60 offen offset:1536 sc1
    buffer_load_dwordx4 v[16:19], v203, s[32:35], s61 offen offset:0 sc1
    buffer_load_dwordx4 v[20:23], v203, s[32:35], s61 offen offset:128 sc1
    buffer_load_dwordx4 v[24:27], v203, s[32:35], s61 offen offset:256 sc1
    buffer_load_dwordx4 v[28:31], v203, s[32:35], s61 offen offset:384 sc1
L_c1chk:
    s_waitcnt vmcnt(4)
    v_xor_b32 v188, s44, v49
    v_bitop3_b32 v188, v51, s44, v188 bitop3:0xbe
    v_cmp_ne_u32 vcc, 0, v188
    s_cbranch_vccz L_c1ok
    s_waitcnt vmcnt(0)
    s_sub_u32 s51, s51, 1
    s_cbranch_scc0 L_c1
L_c1ok:
    v_mov_b32 v52, v48
    s_nop 1
    v_max_f32_dpp v52, v52, v52 quad_perm:[1,0,3,2] row_mask:0xf bank_mask:0xf
    s_nop 1
    v_max_f32_dpp v52, v52, v52 quad_perm:[2,3,0,1] row_mask:0xf bank_mask:0xf
    s_nop 1
    v_max_f32_dpp v52, v52, v52 row_half_mirror row_mask:0xf bank_mask:0xf
    v_sub_f32 v52, v48, v52
    v_mul_f32 v52, s58, v52
    v_exp_f32 v52, v52
    s_nop 0
    v_mul_f32 v53, v52, v50
    s_nop 1
    v_add_f32_dpp v53, v53, v53 quad_perm:[1,0,3,2] row_mask:0xf bank_mask:0xf
    s_nop 1
    v_add_f32_dpp v53, v53, v53 quad_perm:[2,3,0,1] row_mask:0xf bank_mask:0xf
    s_nop 1
    v_add_f32_dpp v53, v53, v53 row_half_mirror row_mask:0xf bank_mask:0xf
    v_rcp_f32 v53, v53
    s_mov_b32 s51, 20000
    v_mul_f32 v52, v52, v53
    s_branch L_c2chk
L_c2:
    buffer_load_dwordx4 v[16:19], v203, s[32:35], s61 offen offset:0 sc1
    buffer_load_dwordx4 v[20:23], v203, s[32:35], s61 offen offset:128 sc1
    buffer_load_dwordx4 v[24:27], v203, s[32:35], s61 offen offset:256 sc1
    buffer_load_dwordx4 v[28:31], v203, s[32:35], s61 offen offset:384 sc1
L_c2chk:
    s_waitcnt vmcnt(0)
    v_xor_b32 v188, s44, v17
    v_bitop3_b32 v188, v19, s44, v188 bitop3:0xbe
    v_bitop3_b32 v188, v21, s44, v188 bitop3:0xbe
    v_bitop3_b32 v188, v23, s44, v188 bitop3:0xbe
    v_bitop3_b32 v188, v25, s44, v188 bitop3:0xbe
    v_bitop3_b32 v188, v27, s44, v188 bitop3:0xbe
    v_bitop3_b32 v188, v29, s44, v188 bitop3:0xbe
    v_bitop3_b32 v188, v31, s44, v188 bitop3:0xbe
    v_cmp_ne_u32 vcc, 0, v188
    s_cbranch_vccz L_c2ok
    s_sub_u32 s51, s51, 1
    s_cbranch_scc0 L_c2
L_c2ok:
    v_mul_f32 v56, v52, v16
    v_mul_f32 v57, v52, v18
    v_mul_f32 v58, v52, v20
    v_mul_f32 v59, v52, v22
    v_mul_f32 v60, v52, v24
    v_mul_f32 v61, v52, v26
    v_mul_f32 v62, v52, v28
    v_mul_f32 v63, v52, v30
    v_add_f32_dpp v56, v56, v56 quad_perm:[1,0,3,2] row_mask:0xf bank_mask:0xf
    v_add_f32_dpp v57, v57, v57 quad_perm:[1,0,3,2] row_mask:0xf bank_mask:0xf
    v_add_f32_dpp v58, v58, v58 quad_perm:[1,0,3,2] row_mask:0xf bank_mask:0xf
    v_add_f32_dpp v59, v59, v59 quad_perm:[1,0,3,2] row_mask:0xf bank_mask:0xf
    v_add_f32_dpp v60, v60, v60 quad_perm:[1,0,3,2] row_mask:0xf bank_mask:0xf
    v_add_f32_dpp v61, v61, v61 quad_perm:[1,0,3,2] row_mask:0xf bank_mask:0xf
    v_add_f32_dpp v62, v62, v62 quad_perm:[1,0,3,2] row_mask:0xf bank_mask:0xf
    v_add_f32_dpp v63, v63, v63 quad_perm:[1,0,3,2] row_mask:0xf bank_mask:0xf
    v_add_f32_dpp v56, v56, v56 quad_perm:[2,3,0,1] row_mask:0xf bank_mask:0xf
    v_add_f32_dpp v57, v57, v57 quad_perm:[2,3,0,1] row_mask:0xf bank_mask:0xf
    v_add_f32_dpp v58, v58, v58 quad_perm:[2,3,0,1] row_mask:0xf bank_mask:0xf
    v_add_f32_dpp v59, v59, v59 quad_perm:[2,3,0,1] row_mask:0xf bank_mask:0xf
    v_add_f32_dpp v60, v60, v60 quad_perm:[2,3,0,1] row_mask:0xf bank_mask:0xf
    v_add_f32_dpp v61, v61, v61 quad_perm:[2,3,0,1] row_mask:0xf bank_mask:0xf
    v_add_f32_dpp v62, v62, v62 quad_perm:[2,3,0,1] row_mask:0xf bank_mask:0xf
    v_add_f32_dpp v63, v63, v63 quad_perm:[2,3,0,1] row_mask:0xf bank_mask:0xf
    v_add_f32_dpp v56, v56, v56 row_half_mirror row_mask:0xf bank_mask:0xf
    v_add_f32_dpp v57, v57, v57 row_half_mirror row_mask:0xf bank_mask:0xf
    v_add_f32_dpp v58, v58, v58 row_half_mirror row_mask:0xf bank_mask:0xf
    v_add_f32_dpp v59, v59, v59 row_half_mirror row_mask:0xf bank_mask:0xf
    v_add_f32_dpp v60, v60, v60 row_half_mirror row_mask:0xf bank_mask:0xf
    v_add_f32_dpp v61, v61, v61 row_half_mirror row_mask:0xf bank_mask:0xf
    v_add_f32_dpp v62, v62, v62 row_half_mirror row_mask:0xf bank_mask:0xf
    v_add_f32_dpp v63, v63, v63 row_half_mirror row_mask:0xf bank_mask:0xf
    v_cvt_pk_bf16_f32 v56, v56, v56
    v_cvt_pk_bf16_f32 v57, v57, v57
    v_cvt_pk_bf16_f32 v58, v58, v58
    v_cvt_pk_bf16_f32 v59, v59, v59
    v_cvt_pk_bf16_f32 v60, v60, v60
    v_cvt_pk_bf16_f32 v61, v61, v61
    v_cvt_pk_bf16_f32 v62, v62, v62
    v_cvt_pk_bf16_f32 v63, v63, v63
    s_branch L_cwr
L_cdn:
    s_mov_b32 s57, s61
    s_add_u32 s56, s57, 131072
    v_cmp_gt_u32 vcc, 5, v3
    s_nop 1
    v_cndmask_b32 v14, 0, v3, vcc
    v_cndmask_b32 v52, 0, 1.0, vcc
    v_lshlrev_b32 v14, 11, v14
    v_lshl_add_u32 v9, v2, 4, v14
    s_mov_b64 exec, 1
    ds_add_u32 v13, v198 offset:8
    s_mov_b64 exec, -1
    s_mov_b32 s51, 20000
Lpoll_16:
    buffer_load_dwordx4 v[16:19], v9, s[32:35], s57 offen offset:0 sc1
    buffer_load_dwordx4 v[20:23], v9, s[32:35], s57 offen offset:128 sc1
    buffer_load_dwordx4 v[24:27], v9, s[32:35], s57 offen offset:256 sc1
    buffer_load_dwordx4 v[28:31], v9, s[32:35], s57 offen offset:384 sc1
    buffer_load_dwordx4 v[32:35], v9, s[32:35], s56 offen offset:0 sc1
    buffer_load_dwordx4 v[36:39], v9, s[32:35], s56 offen offset:128 sc1
    buffer_load_dwordx4 v[40:43], v9, s[32:35], s56 offen offset:256 sc1
    buffer_load_dwordx4 v[44:47], v9, s[32:35], s56 offen offset:384 sc1
    s_waitcnt vmcnt(0)
    v_xor_b32 v188, s44, v17
    v_bitop3_b32 v188, v19, s44, v188 bitop3:0xbe
    v_bitop3_b32 v188, v21, s44, v188 bitop3:0xbe
    v_bitop3_b32 v188, v23, s44, v188 bitop3:0xbe
    v_bitop3_b32 v188, v25, s44, v188 bitop3:0xbe
    v_bitop3_b32 v188, v27, s44, v188 bitop3:0xbe
    v_bitop3_b32 v188, v29, s44, v188 bitop3:0xbe
    v_bitop3_b32 v188, v31, s44, v188 bitop3:0xbe
    v_bitop3_b32 v188, v33, s44, v188 bitop3:0xbe
    v_bitop3_b32 v188, v35, s44, v188 bitop3:0xbe
    v_bitop3_b32 v188, v37, s44, v188 bitop3:0xbe
    v_bitop3_b32 v188, v39, s44, v188 bitop3:0xbe
    v_bitop3_b32 v188, v41, s44, v188 bitop3:0xbe
    v_bitop3_b32 v188, v43, s44, v188 bitop3:0xbe
    v_bitop3_b32 v188, v45, s44, v188 bitop3:0xbe
    v_bitop3_b32 v188, v47, s44, v188 bitop3:0xbe
    v_cmp_ne_u32 vcc, 0, v188
    s_cbranch_vccz Lpollok_17
    s_sub_u32 s51, s51, 1
    s_cbranch_scc0 Lpoll_16
Lpollok_17:
    v_mul_f32 v16, v52, v16
    v_mul_f32 v18, v52, v18
    v_mul_f32 v20, v52, v20
    v_mul_f32 v22, v52, v22
    v_mul_f32 v24, v52, v24
    v_mul_f32 v26, v52, v26
    v_mul_f32 v28, v52, v28
    v_mul_f32 v30, v52, v30
    v_mul_f32 v32, v52, v32
    v_mul_f32 v34, v52, v34
    v_mul_f32 v36, v52, v36
    v_mul_f32 v38, v52, v38
    v_mul_f32 v40, v52, v40
    v_mul_f32 v42, v52, v42
    v_mul_f32 v44, v52, v44
    v_mul_f32 v46, v52, v46
    v_add_f32_dpp v16, v16, v16 quad_perm:[1,0,3,2] row_mask:0xf bank_mask:0xf
    v_add_f32_dpp v18, v18, v18 quad_perm:[1,0,3,2] row_mask:0xf bank_mask:0xf
    v_add_f32_dpp v20, v20, v20 quad_perm:[1,0,3,2] row_mask:0xf bank_mask:0xf
    v_add_f32_dpp v22, v22, v22 quad_perm:[1,0,3,2] row_mask:0xf bank_mask:0xf
    v_add_f32_dpp v24, v24, v24 quad_perm:[1,0,3,2] row_mask:0xf bank_mask:0xf
    v_add_f32_dpp v26, v26, v26 quad_perm:[1,0,3,2] row_mask:0xf bank_mask:0xf
    v_add_f32_dpp v28, v28, v28 quad_perm:[1,0,3,2] row_mask:0xf bank_mask:0xf
    v_add_f32_dpp v30, v30, v30 quad_perm:[1,0,3,2] row_mask:0xf bank_mask:0xf
    v_add_f32_dpp v32, v32, v32 quad_perm:[1,0,3,2] row_mask:0xf bank_mask:0xf
    v_add_f32_dpp v34, v34, v34 quad_perm:[1,0,3,2] row_mask:0xf bank_mask:0xf
    v_add_f32_dpp v36, v36, v36 quad_perm:[1,0,3,2] row_mask:0xf bank_mask:0xf
    v_add_f32_dpp v38, v38, v38 quad_perm:[1,0,3,2] row_mask:0xf bank_mask:0xf
    v_add_f32_dpp v40, v40, v40 quad_perm:[1,0,3,2] row_mask:0xf bank_mask:0xf
    v_add_f32_dpp v42, v42, v42 quad_perm:[1,0,3,2] row_mask:0xf bank_mask:0xf
    v_add_f32_dpp v44, v44, v44 quad_perm:[1,0,3,2] row_mask:0xf bank_mask:0xf
    v_add_f32_dpp v46, v46, v46 quad_perm:[1,0,3,2] row_mask:0xf bank_mask:0xf
    v_add_f32_dpp v16, v16, v16 quad_perm:[2,3,0,1] row_mask:0xf bank_mask:0xf
    v_add_f32_dpp v18, v18, v18 quad_perm:[2,3,0,1] row_mask:0xf bank_mask:0xf
    v_add_f32_dpp v20, v20, v20 quad_perm:[2,3,0,1] row_mask:0xf bank_mask:0xf
    v_add_f32_dpp v22, v22, v22 quad_perm:[2,3,0,1] row_mask:0xf bank_mask:0xf
    v_add_f32_dpp v24, v24, v24 quad_perm:[2,3,0,1] row_mask:0xf bank_mask:0xf
    v_add_f32_dpp v26, v26, v26 quad_perm:[2,3,0,1] row_mask:0xf bank_mask:0xf
    v_add_f32_dpp v28, v28, v28 quad_perm:[2,3,0,1] row_mask:0xf bank_mask:0xf
    v_add_f32_dpp v30, v30, v30 quad_perm:[2,3,0,1] row_mask:0xf bank_mask:0xf
    v_add_f32_dpp v32, v32, v32 quad_perm:[2,3,0,1] row_mask:0xf bank_mask:0xf
    v_add_f32_dpp v34, v34, v34 quad_perm:[2,3,0,1] row_mask:0xf bank_mask:0xf
    v_add_f32_dpp v36, v36, v36 quad_perm:[2,3,0,1] row_mask:0xf bank_mask:0xf
    v_add_f32_dpp v38, v38, v38 quad_perm:[2,3,0,1] row_mask:0xf bank_mask:0xf
    v_add_f32_dpp v40, v40, v40 quad_perm:[2,3,0,1] row_mask:0xf bank_mask:0xf
    v_add_f32_dpp v42, v42, v42 quad_perm:[2,3,0,1] row_mask:0xf bank_mask:0xf
    v_add_f32_dpp v44, v44, v44 quad_perm:[2,3,0,1] row_mask:0xf bank_mask:0xf
    v_add_f32_dpp v46, v46, v46 quad_perm:[2,3,0,1] row_mask:0xf bank_mask:0xf
    v_add_f32_dpp v16, v16, v16 row_half_mirror row_mask:0xf bank_mask:0xf
    v_add_f32_dpp v18, v18, v18 row_half_mirror row_mask:0xf bank_mask:0xf
    v_add_f32_dpp v20, v20, v20 row_half_mirror row_mask:0xf bank_mask:0xf
    v_add_f32_dpp v22, v22, v22 row_half_mirror row_mask:0xf bank_mask:0xf
    v_add_f32_dpp v24, v24, v24 row_half_mirror row_mask:0xf bank_mask:0xf
    v_add_f32_dpp v26, v26, v26 row_half_mirror row_mask:0xf bank_mask:0xf
    v_add_f32_dpp v28, v28, v28 row_half_mirror row_mask:0xf bank_mask:0xf
    v_add_f32_dpp v30, v30, v30 row_half_mirror row_mask:0xf bank_mask:0xf
    v_add_f32_dpp v32, v32, v32 row_half_mirror row_mask:0xf bank_mask:0xf
    v_add_f32_dpp v34, v34, v34 row_half_mirror row_mask:0xf bank_mask:0xf
    v_add_f32_dpp v36, v36, v36 row_half_mirror row_mask:0xf bank_mask:0xf
    v_add_f32_dpp v38, v38, v38 row_half_mirror row_mask:0xf bank_mask:0xf
    v_add_f32_dpp v40, v40, v40 row_half_mirror row_mask:0xf bank_mask:0xf
    v_add_f32_dpp v42, v42, v42 row_half_mirror row_mask:0xf bank_mask:0xf
    v_add_f32_dpp v44, v44, v44 row_half_mirror row_mask:0xf bank_mask:0xf
    v_add_f32_dpp v46, v46, v46 row_half_mirror row_mask:0xf bank_mask:0xf
    v_cvt_pk_bf16_f32 v188, v16, v32
    v_lshlrev_b32 v189, 16, v188
    v_and_b32 v188, s59, v188
    v_mul_f32 v188, v188, v189
    v_cvt_pk_bf16_f32 v56, v188, v188
    v_cvt_pk_bf16_f32 v188, v18, v34
    v_lshlrev_b32 v189, 16, v188
    v_and_b32 v188, s59, v188
    v_mul_f32 v188, v188, v189
    v_cvt_pk_bf16_f32 v57, v188, v188
    v_cvt_pk_bf16_f32 v188, v20, v36
    v_lshlrev_b32 v189, 16, v188
    v_and_b32 v188, s59, v188
    v_mul_f32 v188, v188, v189
    v_cvt_pk_bf16_f32 v58, v188, v188
    v_cvt_pk_bf16_f32 v188, v22, v38
    v_lshlrev_b32 v189, 16, v188
    v_and_b32 v188, s59, v188
    v_mul_f32 v188, v188, v189
    v_cvt_pk_bf16_f32 v59, v188, v188
    v_cvt_pk_bf16_f32 v188, v24, v40
    v_lshlrev_b32 v189, 16, v188
    v_and_b32 v188, s59, v188
    v_mul_f32 v188, v188, v189
    v_cvt_pk_bf16_f32 v60, v188, v188
    v_cvt_pk_bf16_f32 v188, v26, v42
    v_lshlrev_b32 v189, 16, v188
    v_and_b32 v188, s59, v188
    v_mul_f32 v188, v188, v189
    v_cvt_pk_bf16_f32 v61, v188, v188
    v_cvt_pk_bf16_f32 v188, v28, v44
    v_lshlrev_b32 v189, 16, v188
    v_and_b32 v188, s59, v188
    v_mul_f32 v188, v188, v189
    v_cvt_pk_bf16_f32 v62, v188, v188
    v_cvt_pk_bf16_f32 v188, v30, v46
    v_lshlrev_b32 v189, 16, v188
    v_and_b32 v188, s59, v188
    v_mul_f32 v188, v188, v189
    v_cvt_pk_bf16_f32 v63, v188, v188
L_cwr:
    s_mov_b32 s56, 0x01010101
    s_mov_b32 s57, 0x01010101
    s_mov_b64 exec, s[56:57]
    ds_write_b128 v10, v[56:59] offset:2048
    ds_write_b128 v10, v[60:63] offset:2064
    s_mov_b64 exec, 1
    ds_add_u32 v13, v198 offset:4
    s_mov_b64 exec, -1
    s_branch L_done
L_final:
    s_sub_u32 s54, s49, 6
    s_cmp_ge_u32 s54, 20
    s_cbranch_scc1 L_done
    s_mul_i32 s55, s48, 20
    s_add_u32 s64, s55, s54
    s_mov_b32 s40, s4
    s_mov_b32 s41, s5
    s_lshr_b32 s54, s64, 3
    s_lshl_b32 s54, s54, 5
    s_bfe_u32 s55, s64, 0x10002
    s_lshl_b32 s55, s55, 3
    s_add_u32 s54, s54, s55
    s_and_b32 s55, s64, 3
    s_lshl_b32 s55, s55, 1
    s_add_u32 s54, s54, s55
    s_lshl_b32 s67, s54, 1
    v_and_b32 v16, 17, v1
    v_lshlrev_b32 v16, 1, v16
    buffer_load_ushort v17, v16, s[40:43], s67 offen
    v_lshrrev_b32 v18, 1, v1
    v_min_u32 v19, 23, v18
    v_mul_u32_u24 v18, 5120, v18
    v_mul_u32_u24 v19, 5120, v19
    v_and_b32 v8, 1, v1
    v_lshl_add_u32 v18, v8, 4, v18
    v_lshl_add_u32 v19, v8, 4, v19
    v_cmp_gt_u32 vcc, 48, v1
    s_nop 1
    v_cndmask_b32 v20, 0, 1.0, vcc
    s_lshl_b32 s54, s64, 5
    s_add_u32 s54, s54, 65536
    s_add_u32 s55, s54, 163840
    s_add_u32 s56, s54, 327680
    s_add_u32 s57, s54, 491520
    s_mov_b32 s40, s22
    s_mov_b32 s41, s23
    s_mov_b32 s51, 160000
Lspin_18:
    ds_read_b32 v188, v13 offset:12
    s_waitcnt lgkmcnt(0)
    v_readfirstlane_b32 s52, v188
    s_cmp_ge_u32 s52, 1
    s_cbranch_scc1 Lspinok_19
    s_sleep 1
    s_sub_u32 s51, s51, 1
    s_cbranch_scc0 Lspin_18
Lspinok_19:
    s_mov_b32 s51, 20000
    buffer_load_dwordx4 v[48:51], v18, s[32:35], s54 offen sc1
    buffer_load_dwordx4 v[52:55], v18, s[32:35], s55 offen sc1
    buffer_load_dwordx4 v[56:59], v18, s[32:35], s56 offen sc1
    buffer_load_dwordx4 v[60:63], v19, s[32:35], s57 offen sc1
    buffer_load_dwordx4 v[64:67], v18, s[32:35], s54 offen sc1
    buffer_load_dwordx4 v[68:71], v18, s[32:35], s55 offen sc1
    buffer_load_dwordx4 v[72:75], v18, s[32:35], s56 offen sc1
    buffer_load_dwordx4 v[76:79], v19, s[32:35], s57 offen sc1
Lpp_20:
    s_waitcnt vmcnt(4)
    v_xor_b32 v188, s44, v49
    v_bitop3_b32 v188, v51, s44, v188 bitop3:0xbe
    v_bitop3_b32 v188, v53, s44, v188 bitop3:0xbe
    v_bitop3_b32 v188, v55, s44, v188 bitop3:0xbe
    v_bitop3_b32 v188, v57, s44, v188 bitop3:0xbe
    v_bitop3_b32 v188, v59, s44, v188 bitop3:0xbe
    v_bitop3_b32 v188, v61, s44, v188 bitop3:0xbe
    v_bitop3_b32 v188, v63, s44, v188 bitop3:0xbe
    v_cmp_ne_u32 vcc, 0, v188
    s_cbranch_vccz Lppok_22
    buffer_load_dwordx4 v[48:51], v18, s[32:35], s54 offen sc1
    buffer_load_dwordx4 v[52:55], v18, s[32:35], s55 offen sc1
    buffer_load_dwordx4 v[56:59], v18, s[32:35], s56 offen sc1
    buffer_load_dwordx4 v[60:63], v19, s[32:35], s57 offen sc1
    s_waitcnt vmcnt(4)
    v_xor_b32 v188, s44, v65
    v_bitop3_b32 v188, v67, s44, v188 bitop3:0xbe
    v_bitop3_b32 v188, v69, s44, v188 bitop3:0xbe
    v_bitop3_b32 v188, v71, s44, v188 bitop3:0xbe
    v_bitop3_b32 v188, v73, s44, v188 bitop3:0xbe
    v_bitop3_b32 v188, v75, s44, v188 bitop3:0xbe
    v_bitop3_b32 v188, v77, s44, v188 bitop3:0xbe
    v_bitop3_b32 v188, v79, s44, v188 bitop3:0xbe
    v_cmp_ne_u32 vcc, 0, v188
    s_cbranch_vccz Lppok_23
    buffer_load_dwordx4 v[64:67], v18, s[32:35], s54 offen sc1
    buffer_load_dwordx4 v[68:71], v18, s[32:35], s55 offen sc1
    buffer_load_dwordx4 v[72:75], v18, s[32:35], s56 offen sc1
    buffer_load_dwordx4 v[76:79], v19, s[32:35], s57 offen sc1
    s_sub_u32 s51, s51, 1
    s_cbranch_scc0 Lpp_20
    s_waitcnt vmcnt(0)
Lppok_22:
    v_add_f32 v24, v48, v52
    v_add_f32 v26, v50, v54
    v_mul_f32 v36, v20, v60
    v_mul_f32 v38, v20, v62
    v_add_f32 v24, v24, v56
    v_add_f32 v26, v26, v58
    s_branch Lppc_21
Lppok_23:
    v_add_f32 v24, v64, v68
    v_add_f32 v26, v66, v70
    v_mul_f32 v36, v20, v76
    v_mul_f32 v38, v20, v78
    v_add_f32 v24, v24, v72
    v_add_f32 v26, v26, v74
Lppc_21:
    s_nop 1
    v_permlane32_swap_b32 v24, v36
    v_permlane32_swap_b32 v26, v38
    s_nop 0
    v_add_f32 v24, v24, v36
    v_add_f32 v26, v26, v38
    s_nop 1
    v_permlane16_swap_b32 v24, v26
    s_nop 0
    v_add_f32 v24, v24, v26
    s_nop 1
    v_add_f32_dpp v24, v24, v24 quad_perm:[2,3,0,1] row_mask:0xf bank_mask:0xf
    s_nop 1
    v_add_f32_dpp v24, v24, v24 row_ror:4 row_mask:0xf bank_mask:0xf
    s_nop 1
    v_add_f32_dpp v24, v24, v24 row_ror:8 row_mask:0xf bank_mask:0xf
    v_mov_b32 v25, v24
    s_nop 1
    v_permlane32_swap_b32 v24, v25
    s_nop 0
    v_cvt_pk_bf16_f32 v188, v24, v25
    v_lshlrev_b32 v24, 16, v188
    v_and_b32 v25, s59, v188
    v_mul_f32 v26, s58, v25
    v_exp_f32 v26, -v26
    s_nop 0
    v_add_f32 v26, 1.0, v26
    v_rcp_f32 v26, v26
    s_nop 0
    v_mul_f32 v26, v25, v26
    v_cvt_pk_bf16_f32 v26, v26, v26
    v_lshlrev_b32 v26, 16, v26
    v_mul_f32 v26, v24, v26
    v_cvt_pk_bf16_f32 v26, v26, v26
    v_lshlrev_b32 v26, 16, v26
    v_lshlrev_b32 v17, 16, v17
    v_add_f32 v26, v17, v26
    v_cvt_pk_bf16_f32 v26, v26, v26
    s_mov_b64 exec, 0x30003
    buffer_store_short v26, v16, s[40:43], s67 offen
    s_mov_b64 exec, -1
    s_cmp_lg_u32 s64, 0
    s_cbranch_scc1 L_done
    v_mov_b32 v188, s44
    s_mov_b64 exec, 1
    buffer_store_dword v188, v13, s[32:35], 0 offen
    s_mov_b64 exec, -1
L_done:
L_end:
    s_endpgm
L_codeend:

.section .rodata,"a"
.p2align 6
.amdhsa_kernel recurrent_scan__sliding_block_cached__glu_gated_bilinear__decode_kernel
  .amdhsa_next_free_vgpr 208
  .amdhsa_next_free_sgpr 96
  .amdhsa_accum_offset 208
  .amdhsa_group_segment_fixed_size 0
  .amdhsa_kernarg_size 96
  .amdhsa_user_sgpr_count 2
  .amdhsa_user_sgpr_kernarg_segment_ptr 1
  .amdhsa_system_sgpr_workgroup_id_x 1
.end_amdhsa_kernel
```
